```python
import torch

def _softmax(x, axis=-1):
    return torch.softmax(x, dim=axis)

def _gelu(x):
    return torch.nn.functional.gelu(x, approximate='tanh')

def _silu(x):
    return torch.nn.functional.silu(x)

def _sigmoid(x):
    return torch.sigmoid(x)

def _layernorm(x, axis=-1, eps=1e-05):
    m = x.mean(dim=axis, keepdim=True)
    v = x.var(dim=axis, keepdim=True, unbiased=False)
    return (x - m) / torch.sqrt(v + eps)

def _scatter_add(tgt, idx, src, axis=0):
    return tgt.clone().index_add_(axis, idx, src)

def _segment_sum(src, seg, n):
    out = torch.zeros((n,) + src.shape[1:], dtype=src.dtype)
    return out.index_add_(0, seg, src)

def _pad(x, pw):
    flat = tuple((v for pair in reversed(pw) for v in pair))
    return torch.nn.functional.pad(x, flat)
kernel_name = 'gated_mix__ssm_conv_s4d__mixer_gmlp__prompt'

def setup_inputs():

    _w = lambda a: (lambda t: t.to(torch.bfloat16) if t.is_floating_point() else t)(torch.as_tensor(a))

    def _A_setup():
        Bsz, L, D, N = (1, 2048, 512, 128)
        return {'u': _w((lambda *s: torch.randn(*s, dtype=torch.bfloat16) * 0.05)(Bsz, L, D)), 'log_A_real': _w((lambda *s: torch.randn(*s, dtype=torch.bfloat16) * 12.8)(D, N) * 0.5), 'A_imag': _w((lambda *s: torch.randn(*s, dtype=torch.bfloat16) * 0.05)(D, N) * 3.14), 'C_real': _w((lambda *s: torch.randn(*s, dtype=torch.bfloat16) * 1.6)(D, N) / N ** 0.5), 'C_imag': _w((lambda *s: torch.randn(*s, dtype=torch.bfloat16) * 3.2)(D, N) / N ** 0.5), 'log_dt': _w((lambda *s: torch.randn(*s, dtype=torch.bfloat16) * 0.05)(D) * 0.5 - 4.0), 'D_skip': _w((lambda *s: torch.randn(*s, dtype=torch.bfloat16) * 0.8)(D))}
    _A_in = _A_setup()

    def _B_setup():
        B, S, D, F = (1, 2048, 512, 1792)
        Fh = F // 2
        return {'x': _w((lambda *s: torch.randn(*s, dtype=torch.bfloat16) * 0.05)(B, S, D)), 'w_in': _w((lambda *s: torch.randn(*s, dtype=torch.bfloat16) * 0.4)(D, 2 * Fh)), 'w_sp': _w(0.01 * (lambda *s: torch.randn(*s, dtype=torch.bfloat16) * 0.4)(S, S)), 'b_sp': _w(1.0 + 0.01 * (lambda *s: torch.randn(*s, dtype=torch.bfloat16) * 0.05)(S)), 'w_out': _w((lambda *s: torch.randn(*s, dtype=torch.bfloat16) * 0.05)(Fh, D))}
    _B_in = _B_setup()
    return {'A_u': _A_in['u'], 'A_log_A_real': _A_in['log_A_real'], 'A_A_imag': _A_in['A_imag'], 'A_C_real': _A_in['C_real'], 'A_C_imag': _A_in['C_imag'], 'A_log_dt': _A_in['log_dt'], 'A_D_skip': _A_in['D_skip'], 'B_x': _B_in['x'], 'B_w_in': _B_in['w_in'], 'B_w_sp': _B_in['w_sp'], 'B_b_sp': _B_in['b_sp'], 'B_w_out': _B_in['w_out'], 'gate_w': _w((lambda *s: torch.randn(*s, dtype=torch.bfloat16) * 0.05)(512) * 16.0)}

def reference(A_u, A_log_A_real, A_A_imag, A_C_real, A_C_imag, A_log_dt, A_D_skip, B_x, B_w_in, B_w_sp, B_b_sp, B_w_out, gate_w):

    def _A_ref(u, log_A_real, A_imag, C_real, C_imag, log_dt, D_skip):
        L = u.shape[1]
        dt = torch.exp(log_dt)
        A = -torch.exp(log_A_real) + 1j * A_imag
        C = (C_real + 1j * C_imag) * dt[:, None]
        pos = (lambda x, dt: x.to(dt))(torch.arange(L), log_dt.dtype)
        P = torch.exp((A * dt[:, None])[:, :, None] * pos[None, None, :])
        K = 2.0 * torch.einsum('dn,dnl->dl', C, P).real
        L2 = 2 * L
        u_t = (lambda x, *d: x.permute(*d))(u, 0, 2, 1)
        Kf = (lambda x, *a, **k: torch.fft.rfft(x.float(), *a, **k))(K, L2)
        Uf = (lambda x, *a, **k: torch.fft.rfft(x.float(), *a, **k))(u_t, L2)
        y = (lambda x, *a, **k: torch.fft.irfft(x, *a, **k).to(torch.bfloat16))(Uf * Kf[None, :, :], L2)[:, :, :L]
        y = (lambda x, *d: x.permute(*d))(y, 0, 2, 1)
        return y + u * D_skip[None, None, :]

    def _B_ref(x, w_in, w_sp, b_sp, w_out):
        B, S, D = x.shape
        F = w_in.shape[-1]
        Fh = F // 2
        z = _gelu(torch.einsum('bsd,df->bsf', x, w_in))
        z1 = z[..., :Fh].clone()
        z2 = _layernorm(z[..., Fh:], axis=-1)
        g = torch.einsum('ts,bsf->btf', w_sp, z2) + b_sp[None, :, None]
        return torch.einsum('bsf,fd->bsd', z1 * g, w_out)
    x = A_u
    g = _sigmoid((x * gate_w).sum(-1, keepdims=True))
    a = _A_ref(x, A_log_A_real, A_A_imag, A_C_real, A_C_imag, A_log_dt, A_D_skip)
    b = _B_ref(x, B_w_in, B_w_sp, B_b_sp, B_w_out)
    return g * a + (1 - g) * b
```

```asm
; @launch grid=(256,1,1) block=(512,1,1) lds=163840
.amdgcn_target "amdgcn-amd-amdhsa--gfx950"
.text
.globl gated_mix__ssm_conv_s4d__mixer_gmlp__prompt_kernel
.p2align 8
.type gated_mix__ssm_conv_s4d__mixer_gmlp__prompt_kernel,@function
gated_mix__ssm_conv_s4d__mixer_gmlp__prompt_kernel:
    s_cmp_ge_u32 s2, 256
    s_cbranch_scc1 L_end
    s_load_dwordx16 s[24:39], s[0:1], 0
    s_load_dwordx16 s[40:55], s[0:1], 64
    v_lshrrev_b32 v1, 6, v0
    v_and_b32 v0, 63, v0
    v_mov_b32 v3, 0
    v_readfirstlane_b32 s3, v1
    s_and_b32 s20, s2, 7
    s_lshr_b32 s21, s2, 3
    s_lshr_b32 s22, s20, 1
    s_lshl_b32 s22, s22, 3
    s_lshr_b32 s23, s21, 2
    s_add_u32 s4, s22, s23
    s_and_b32 s22, s20, 1
    s_lshl_b32 s22, s22, 2
    s_and_b32 s23, s21, 3
    s_add_u32 s5, s22, s23
    s_lshr_b32 s59, s3, 2
    s_and_b32 s60, s3, 3
    s_lshl_b32 s61, s3, 10
    s_lshl_b32 s62, s4, 16
    s_lshl_b32 s63, s3, 11
    s_lshl_b32 s64, s5, 8
    s_add_u32 s64, s64, 1792
    s_lshl_b32 s65, s5, 8
    s_mov_b32 s67, 0
    s_lshl_b32 s20, s5, 7
    s_lshl_b32 s21, s4, 2
    s_add_u32 s68, s20, s21
    v_lshrrev_b32 v14, 3, v0
    s_lshl_b32 s20, s3, 3
    v_add_u32 v14, s20, v14
    v_bfe_u32 v15, v14, 1, 3
    v_lshrrev_b32 v16, 3, v14
    v_and_b32 v16, 2, v16
    v_xor_b32 v15, v15, v16
    v_and_b32 v16, 7, v0
    v_xor_b32 v15, v15, v16
    v_lshlrev_b32 v15, 4, v15
    v_lshl_add_u32 v1, v14, 10, v15
    v_lshrrev_b32 v14, 4, v0
    s_and_b32 s21, s3, 1
    s_lshl_b32 s21, s21, 2
    v_or_b32 v15, s21, v14
    v_lshlrev_b32 v15, 1, v15
    v_and_b32 v16, 15, v0
    v_xor_b32 v15, v15, v16
    v_lshlrev_b32 v15, 4, v15
    v_add_u32 v14, s20, v14
    v_mul_u32_u24 v14, 3584, v14
    v_add_u32 v2, v14, v15
    s_waitcnt lgkmcnt(0)
    s_mov_b32 s8, s24
    s_and_b32 s9, s25, 0xffff
    s_mov_b32 s10, 2097152
    s_mov_b32 s11, 0x20000
    s_mov_b32 s12, s40
    s_and_b32 s13, s41, 0xffff
    s_mov_b32 s14, 1835008
    s_mov_b32 s15, 0x20000
    s_mov_b32 s52, 0x10000000
    s_mul_i32 s38, s4, 1
    s_add_u32 s38, s38, s5
    s_and_b32 s38, s38, 7
    s_mul_i32 s39, s4, 1
    s_cmp_eq_u32 s5, 7
    s_cbranch_scc1 L_role7
    s_add_u32 s21, s39, 0
    s_and_b32 s21, s21, 7
    s_lshl_b32 s21, s21, 7
    s_add_u32 s21, s21, s62
    s_add_u32 m0, s61, 0
    s_nop 0
    buffer_load_dwordx4 v1, s[8:11], s21 offen lds
    s_add_u32 s21, s39, 0
    s_and_b32 s21, s21, 7
    s_mul_i32 s21, s21, 229376
    s_add_u32 s21, s21, s64
    s_add_u32 m0, s63, 65536
    s_nop 0
    buffer_load_dwordx4 v2, s[12:15], s21 offen lds
    s_add_u32 s21, s21, 14336
    s_add_u32 m0, s63, 66560
    s_nop 0
    buffer_load_dwordx4 v2, s[12:15], s21 offen lds
    s_cmp_ge_u32 s3, 4
    s_cbranch_scc1 L_ep_1
    v_and_b32 v14, 15, v0
    s_lshl_b32 s20, s4, 6
    v_add_u32 v14, s20, v14
    v_lshlrev_b32 v14, 1, v14
    global_load_ushort v250, v14, s[44:45] offset:0
    global_load_ushort v251, v14, s[44:45] offset:32
    global_load_ushort v252, v14, s[44:45] offset:64
    global_load_ushort v253, v14, s[44:45] offset:96
    s_branch L_epd_2
L_ep_1:
    s_lshl_b32 s20, s68, 7
    s_sub_u32 s21, s3, 4
    s_lshl_b32 s21, s21, 7
    s_add_u32 s20, s20, s21
    v_lshl_add_u32 v14, v0, 1, s20
    global_load_ushort v250, v14, s[26:27]
    global_load_ushort v251, v14, s[28:29]
    global_load_ushort v252, v14, s[30:31]
    global_load_ushort v253, v14, s[32:33]
L_epd_2:
    s_add_u32 s21, s39, 1
    s_and_b32 s21, s21, 7
    s_lshl_b32 s21, s21, 7
    s_add_u32 s21, s21, s62
    s_add_u32 m0, s61, 8192
    s_nop 0
    buffer_load_dwordx4 v1, s[8:11], s21 offen lds
    s_add_u32 s21, s39, 1
    s_and_b32 s21, s21, 7
    s_mul_i32 s21, s21, 229376
    s_add_u32 s21, s21, s64
    s_add_u32 m0, s63, 81920
    s_nop 0
    buffer_load_dwordx4 v2, s[12:15], s21 offen lds
    s_add_u32 s21, s21, 14336
    s_add_u32 m0, s63, 82944
    s_nop 0
    buffer_load_dwordx4 v2, s[12:15], s21 offen lds
    s_getpc_b64 s[72:73]
L_pc_3:
    s_lshr_b32 s22, s2, 3
    s_mul_i32 s22, s22, 12
    s_and_b32 s23, s3, 7
    s_lshl_b32 s23, s23, 1
    s_add_u32 s22, s22, s23
    s_lshl_b32 s22, s22, 7
    v_lshl_add_u32 v18, v0, 7, s22
    v_min_u32 v18, L_end-L_pc_3, v18
    s_cmp_lt_u32 s3, 6
    s_cselect_b32 exec_lo, 3, 1
    s_mov_b32 exec_hi, 0
    global_load_dword v255, v18, s[72:73]
    s_mov_b64 exec, -1
    s_mov_b32 s16, s54
    s_and_b32 s17, s55, 0xffff
    s_mov_b32 s18, 268435456
    s_mov_b32 s19, 0x20000
    s_load_dword s56, s[54:55], 0
    s_load_dword s57, s[34:35], s68
    s_load_dword s58, s[36:37], s68
    v_mov_b32 v12, 0xc0135761
    v_and_b32 v14, 15, v0
    v_lshrrev_b32 v15, 4, v0
    s_lshl_b32 s20, s59, 5
    v_lshrrev_b32 v16, 2, v14
    v_lshlrev_b32 v16, 3, v16
    v_and_b32 v17, 3, v14
    v_add3_u32 v16, v16, v17, s20
    v_bfe_u32 v17, v16, 1, 3
    v_lshrrev_b32 v18, 3, v16
    v_and_b32 v18, 2, v18
    v_xor_b32 v17, v17, v18
    v_xor_b32 v17, v17, v15
    v_lshlrev_b32 v17, 4, v17
    v_lshl_add_u32 v4, v16, 7, v17
    v_xor_b32 v5, 64, v4
    v_lshrrev_b32 v16, 2, v14
    v_lshlrev_b32 v16, 3, v16
    v_and_b32 v17, 3, v14
    v_add3_u32 v16, v16, v17, s20
    v_add_u32 v16, 4, v16
    v_bfe_u32 v17, v16, 1, 3
    v_lshrrev_b32 v18, 3, v16
    v_and_b32 v18, 2, v18
    v_xor_b32 v17, v17, v18
    v_xor_b32 v17, v17, v15
    v_lshlrev_b32 v17, 4, v17
    v_lshl_add_u32 v6, v16, 7, v17
    v_xor_b32 v7, 64, v6
    v_lshrrev_b32 v14, 4, v0
    v_bfe_u32 v15, v0, 2, 2
    v_and_b32 v16, 3, v0
    v_lshl_add_u32 v17, v14, 3, v15
    v_lshlrev_b32 v17, 8, v17
    v_lshl_add_u32 v17, v16, 3, v17
    v_add_u32 v17, 65536, v17
    v_and_b32 v14, 1, v14
    v_lshl_or_b32 v15, v14, 2, v15
    s_lshl_b32 s20, s60, 1
    v_xor_b32 v18, s20, v15
    v_lshl_add_u32 v8, v18, 5, v17
    v_add_u32 v10, 65536, v8
    s_add_u32 s20, s20, 1
    s_and_b32 s20, s20, 7
    v_xor_b32 v18, s20, v15
    v_lshl_add_u32 v9, v18, 5, v17
    v_add_u32 v11, 65536, v9
    v_lshrrev_b32 v14, 4, v0
    v_bfe_u32 v15, v0, 2, 2
    v_and_b32 v16, 3, v0
    v_lshl_add_u32 v17, v14, 3, v15
    v_lshlrev_b32 v17, 8, v17
    v_lshl_add_u32 v17, v16, 3, v17
    v_add_u32 v17, 65536, v17
    v_and_b32 v14, 1, v14
    v_lshl_or_b32 v15, v14, 2, v15
    s_lshl_b32 s20, s60, 1
    s_add_u32 s20, s20, s67
    v_xor_b32 v18, s20, v15
    v_lshl_add_u32 v52, v18, 5, v17
    v_add_u32 v54, 65536, v52
    v_add_u32 v56, -65536, v52
    s_add_u32 s20, s20, 1
    s_and_b32 s20, s20, 7
    v_xor_b32 v18, s20, v15
    v_lshl_add_u32 v53, v18, 5, v17
    v_add_u32 v55, 65536, v53
    v_add_u32 v57, -65536, v53
    v_and_b32 v14, 15, v0
    v_lshrrev_b32 v15, 3, v14
    v_mul_u32_u24 v15, 3584, v15
    v_bfe_u32 v16, v0, 2, 1
    v_lshlrev_b32 v16, 3, v16
    v_and_b32 v17, 3, v0
    v_and_b32 v18, 48, v0
    v_add3_u32 v16, v16, v17, v18
    v_lshl_add_u32 v15, v16, 3, v15
    s_mul_i32 s20, s59, 7168
    s_lshl_b32 s21, s60, 10
    s_add_u32 s20, s20, s21
    s_add_u32 s20, s20, 147456
    v_add_u32 v58, s20, v15
    v_lshrrev_b32 v13, 2, v0
    v_lshlrev_b32 v13, 4, v13
    s_lshl_b32 s20, s59, 8
    s_lshl_b32 s21, s60, 9
    s_add_u32 s20, s20, s21
    s_add_u32 s20, s20, 147456
    v_add_u32 v13, s20, v13
    s_waitcnt vmcnt(4)
    s_barrier
    ds_read_b128 v[60:63], v4 offset:0
    ds_read_b128 v[64:67], v6 offset:0
    ds_read_b64_tr_b16 v[188:189], v8 offset:0
    ds_read_b64_tr_b16 v[190:191], v8 offset:1024
    ds_read_b64_tr_b16 v[192:193], v9 offset:0
    ds_read_b64_tr_b16 v[194:195], v9 offset:1024
    ds_read_b128 v[68:71], v5 offset:0
    ds_read_b128 v[72:75], v7 offset:0
    ds_read_b64_tr_b16 v[196:197], v8 offset:8192
    ds_read_b64_tr_b16 v[198:199], v8 offset:9216
    ds_read_b64_tr_b16 v[200:201], v9 offset:8192
    ds_read_b64_tr_b16 v[202:203], v9 offset:9216
    s_add_u32 s21, s39, 2
    s_and_b32 s21, s21, 7
    s_lshl_b32 s21, s21, 7
    s_add_u32 s21, s21, s62
    s_add_u32 m0, s61, 16384
    s_nop 0
    buffer_load_dwordx4 v1, s[8:11], s21 offen lds
    s_add_u32 s21, s39, 2
    s_and_b32 s21, s21, 7
    s_mul_i32 s21, s21, 229376
    s_add_u32 s21, s21, s64
    s_add_u32 m0, s63, 98304
    s_nop 0
    buffer_load_dwordx4 v2, s[12:15], s21 offen lds
    s_add_u32 s21, s21, 14336
    s_add_u32 m0, s63, 99328
    s_nop 0
    buffer_load_dwordx4 v2, s[12:15], s21 offen lds
    s_waitcnt vmcnt(4) lgkmcnt(0)
    s_barrier
    v_mfma_f32_16x16x32_bf16 v[20:23], v[60:63], v[188:191], 0
    ds_read_b128 v[76:79], v4 offset:8192
    ds_read_b128 v[80:83], v6 offset:8192
    v_mfma_f32_16x16x32_bf16 v[24:27], v[60:63], v[192:195], 0
    ds_read_b64_tr_b16 v[204:205], v8 offset:16384
    ds_read_b64_tr_b16 v[206:207], v8 offset:17408
    s_add_u32 s21, s39, 3
    s_and_b32 s21, s21, 7
    s_lshl_b32 s21, s21, 7
    s_add_u32 s21, s21, s62
    s_add_u32 m0, s61, 24576
    s_nop 0
    buffer_load_dwordx4 v1, s[8:11], s21 offen lds
    s_add_u32 s21, s39, 3
    s_and_b32 s21, s21, 7
    s_mul_i32 s21, s21, 229376
    s_add_u32 s21, s21, s64
    s_add_u32 m0, s63, 114688
    s_nop 0
    buffer_load_dwordx4 v2, s[12:15], s21 offen lds
    v_mfma_f32_16x16x32_bf16 v[28:31], v[64:67], v[188:191], 0
    ds_read_b64_tr_b16 v[208:209], v9 offset:16384
    ds_read_b64_tr_b16 v[210:211], v9 offset:17408
    s_add_u32 s21, s21, 14336
    s_add_u32 m0, s63, 115712
    s_nop 0
    buffer_load_dwordx4 v2, s[12:15], s21 offen lds
    v_mfma_f32_16x16x32_bf16 v[32:35], v[64:67], v[192:195], 0
    ds_read_b128 v[84:87], v5 offset:8192
    ds_read_b128 v[88:91], v7 offset:8192
    s_add_u32 s21, s39, 4
    s_and_b32 s21, s21, 7
    s_lshl_b32 s21, s21, 7
    s_add_u32 s21, s21, s62
    s_add_u32 m0, s61, 32768
    s_nop 0
    buffer_load_dwordx4 v1, s[8:11], s21 offen lds
    v_mfma_f32_16x16x32_bf16 v[20:23], v[68:71], v[196:199], v[20:23]
    ds_read_b64_tr_b16 v[212:213], v8 offset:24576
    ds_read_b64_tr_b16 v[214:215], v8 offset:25600
    s_add_u32 s21, s39, 4
    s_and_b32 s21, s21, 7
    s_mul_i32 s21, s21, 229376
    s_add_u32 s21, s21, s64
    s_add_u32 m0, s63, 131072
    s_nop 0
    buffer_load_dwordx4 v2, s[12:15], s21 offen lds
    s_add_u32 s21, s21, 14336
    s_add_u32 m0, s63, 132096
    s_nop 0
    buffer_load_dwordx4 v2, s[12:15], s21 offen lds
    v_mfma_f32_16x16x32_bf16 v[24:27], v[68:71], v[200:203], v[24:27]
    ds_read_b64_tr_b16 v[216:217], v9 offset:24576
    ds_read_b64_tr_b16 v[218:219], v9 offset:25600
    s_add_u32 s21, s39, 5
    s_and_b32 s21, s21, 7
    s_mul_i32 s21, s21, 229376
    s_add_u32 s21, s21, s64
    s_add_u32 m0, s63, 65536
    s_nop 0
    buffer_load_dwordx4 v2, s[12:15], s21 offen lds
    v_mfma_f32_16x16x32_bf16 v[28:31], v[72:75], v[196:199], v[28:31]
    s_add_u32 s21, s21, 14336
    s_add_u32 m0, s63, 66560
    s_nop 0
    buffer_load_dwordx4 v2, s[12:15], s21 offen lds
    v_mfma_f32_16x16x32_bf16 v[32:35], v[72:75], v[200:203], v[32:35]
    s_waitcnt vmcnt(8) lgkmcnt(0)
    s_barrier
    v_mfma_f32_16x16x32_bf16 v[20:23], v[76:79], v[204:207], v[20:23]
    ds_read_b128 v[92:95], v4 offset:16384
    ds_read_b128 v[96:99], v6 offset:16384
    v_mfma_f32_16x16x32_bf16 v[24:27], v[76:79], v[208:211], v[24:27]
    ds_read_b64_tr_b16 v[188:189], v8 offset:32768
    ds_read_b64_tr_b16 v[190:191], v8 offset:33792
    s_add_u32 s21, s39, 5
    s_and_b32 s21, s21, 7
    s_lshl_b32 s21, s21, 7
    s_add_u32 s21, s21, s62
    s_add_u32 m0, s61, 40960
    s_nop 0
    buffer_load_dwordx4 v1, s[8:11], s21 offen lds
    v_mfma_f32_16x16x32_bf16 v[28:31], v[80:83], v[204:207], v[28:31]
    ds_read_b64_tr_b16 v[192:193], v9 offset:32768
    ds_read_b64_tr_b16 v[194:195], v9 offset:33792
    s_add_u32 s21, s39, 6
    s_and_b32 s21, s21, 7
    s_lshl_b32 s21, s21, 7
    s_add_u32 s21, s21, s62
    s_add_u32 m0, s61, 49152
    s_nop 0
    buffer_load_dwordx4 v1, s[8:11], s21 offen lds
    v_mfma_f32_16x16x32_bf16 v[32:35], v[80:83], v[208:211], v[32:35]
    ds_read_b128 v[100:103], v5 offset:16384
    ds_read_b128 v[104:107], v7 offset:16384
    v_mfma_f32_16x16x32_bf16 v[20:23], v[84:87], v[212:215], v[20:23]
    ds_read_b64_tr_b16 v[196:197], v8 offset:40960
    ds_read_b64_tr_b16 v[198:199], v8 offset:41984
    s_add_u32 s21, s39, 6
    s_and_b32 s21, s21, 7
    s_mul_i32 s21, s21, 229376
    s_add_u32 s21, s21, s64
    s_add_u32 m0, s63, 81920
    s_nop 0
    buffer_load_dwordx4 v2, s[12:15], s21 offen lds
    v_mfma_f32_16x16x32_bf16 v[24:27], v[84:87], v[216:219], v[24:27]
    ds_read_b64_tr_b16 v[200:201], v9 offset:40960
    ds_read_b64_tr_b16 v[202:203], v9 offset:41984
    s_add_u32 s21, s21, 14336
    s_add_u32 m0, s63, 82944
    s_nop 0
    buffer_load_dwordx4 v2, s[12:15], s21 offen lds
    v_mfma_f32_16x16x32_bf16 v[28:31], v[88:91], v[212:215], v[28:31]
    v_mfma_f32_16x16x32_bf16 v[32:35], v[88:91], v[216:219], v[32:35]
    s_waitcnt vmcnt(9) lgkmcnt(0)
    s_barrier
    v_mfma_f32_16x16x32_bf16 v[20:23], v[92:95], v[188:191], v[20:23]
    ds_read_b128 v[108:111], v4 offset:24576
    ds_read_b128 v[112:115], v6 offset:24576
    v_mfma_f32_16x16x32_bf16 v[24:27], v[92:95], v[192:195], v[24:27]
    ds_read_b64_tr_b16 v[204:205], v8 offset:49152
    ds_read_b64_tr_b16 v[206:207], v8 offset:50176
    s_add_u32 s21, s39, 7
    s_and_b32 s21, s21, 7
    s_lshl_b32 s21, s21, 7
    s_add_u32 s21, s21, s62
    s_add_u32 m0, s61, 57344
    s_nop 0
    buffer_load_dwordx4 v1, s[8:11], s21 offen lds
    v_mfma_f32_16x16x32_bf16 v[28:31], v[96:99], v[188:191], v[28:31]
    ds_read_b64_tr_b16 v[208:209], v9 offset:49152
    ds_read_b64_tr_b16 v[210:211], v9 offset:50176
    v_mfma_f32_16x16x32_bf16 v[32:35], v[96:99], v[192:195], v[32:35]
    ds_read_b128 v[116:119], v5 offset:24576
    ds_read_b128 v[120:123], v7 offset:24576
    s_add_u32 s21, s39, 7
    s_and_b32 s21, s21, 7
    s_mul_i32 s21, s21, 229376
    s_add_u32 s21, s21, s64
    s_add_u32 m0, s63, 98304
    s_nop 0
    buffer_load_dwordx4 v2, s[12:15], s21 offen lds
    v_mfma_f32_16x16x32_bf16 v[20:23], v[100:103], v[196:199], v[20:23]
    ds_read_b64_tr_b16 v[212:213], v8 offset:57344
    ds_read_b64_tr_b16 v[214:215], v8 offset:58368
    v_mfma_f32_16x16x32_bf16 v[24:27], v[100:103], v[200:203], v[24:27]
    ds_read_b64_tr_b16 v[216:217], v9 offset:57344
    ds_read_b64_tr_b16 v[218:219], v9 offset:58368
    s_add_u32 s21, s21, 14336
    s_add_u32 m0, s63, 99328
    s_nop 0
    buffer_load_dwordx4 v2, s[12:15], s21 offen lds
    v_mfma_f32_16x16x32_bf16 v[28:31], v[104:107], v[196:199], v[28:31]
    v_mfma_f32_16x16x32_bf16 v[32:35], v[104:107], v[200:203], v[32:35]
    s_waitcnt vmcnt(9) lgkmcnt(0)
    s_barrier
    v_mfma_f32_16x16x32_bf16 v[20:23], v[108:111], v[204:207], v[20:23]
    ds_read_b128 v[124:127], v4 offset:32768
    ds_read_b128 v[128:131], v6 offset:32768
    v_mfma_f32_16x16x32_bf16 v[24:27], v[108:111], v[208:211], v[24:27]
    ds_read_b64_tr_b16 v[188:189], v10 offset:0
    ds_read_b64_tr_b16 v[190:191], v10 offset:1024
    s_add_u32 s21, s39, 0
    s_and_b32 s21, s21, 7
    s_mul_i32 s21, s21, 229376
    s_add_u32 s21, s21, s65
    s_add_u32 m0, s63, 114688
    s_nop 0
    buffer_load_dwordx4 v2, s[12:15], s21 offen lds
    v_mfma_f32_16x16x32_bf16 v[28:31], v[112:115], v[204:207], v[28:31]
    ds_read_b64_tr_b16 v[192:193], v11 offset:0
    ds_read_b64_tr_b16 v[194:195], v11 offset:1024
    v_mfma_f32_16x16x32_bf16 v[32:35], v[112:115], v[208:211], v[32:35]
    ds_read_b128 v[132:135], v5 offset:32768
    ds_read_b128 v[136:139], v7 offset:32768
    v_mfma_f32_16x16x32_bf16 v[20:23], v[116:119], v[212:215], v[20:23]
    ds_read_b64_tr_b16 v[196:197], v10 offset:8192
    ds_read_b64_tr_b16 v[198:199], v10 offset:9216
    s_add_u32 s21, s21, 14336
    s_add_u32 m0, s63, 115712
    s_nop 0
    buffer_load_dwordx4 v2, s[12:15], s21 offen lds
    v_mfma_f32_16x16x32_bf16 v[24:27], v[116:119], v[216:219], v[24:27]
    ds_read_b64_tr_b16 v[200:201], v11 offset:8192
    ds_read_b64_tr_b16 v[202:203], v11 offset:9216
    v_mfma_f32_16x16x32_bf16 v[28:31], v[120:123], v[212:215], v[28:31]
    v_mfma_f32_16x16x32_bf16 v[32:35], v[120:123], v[216:219], v[32:35]
    s_waitcnt vmcnt(8) lgkmcnt(0)
    s_barrier
    v_mfma_f32_16x16x32_bf16 v[20:23], v[124:127], v[188:191], v[20:23]
    ds_read_b128 v[140:143], v4 offset:40960
    ds_read_b128 v[144:147], v6 offset:40960
    v_mfma_f32_16x16x32_bf16 v[24:27], v[124:127], v[192:195], v[24:27]
    ds_read_b64_tr_b16 v[204:205], v8 offset:0
    ds_read_b64_tr_b16 v[206:207], v8 offset:1024
    s_add_u32 s21, s39, 1
    s_and_b32 s21, s21, 7
    s_mul_i32 s21, s21, 229376
    s_add_u32 s21, s21, s65
    s_add_u32 m0, s63, 131072
    s_nop 0
    buffer_load_dwordx4 v2, s[12:15], s21 offen lds
    v_mfma_f32_16x16x32_bf16 v[28:31], v[128:131], v[188:191], v[28:31]
    ds_read_b64_tr_b16 v[208:209], v9 offset:0
    ds_read_b64_tr_b16 v[210:211], v9 offset:1024
    v_mfma_f32_16x16x32_bf16 v[32:35], v[128:131], v[192:195], v[32:35]
    ds_read_b128 v[148:151], v5 offset:40960
    ds_read_b128 v[152:155], v7 offset:40960
    v_mfma_f32_16x16x32_bf16 v[20:23], v[132:135], v[196:199], v[20:23]
    ds_read_b64_tr_b16 v[212:213], v8 offset:8192
    ds_read_b64_tr_b16 v[214:215], v8 offset:9216
    s_add_u32 s21, s21, 14336
    s_add_u32 m0, s63, 132096
    s_nop 0
    buffer_load_dwordx4 v2, s[12:15], s21 offen lds
    v_mfma_f32_16x16x32_bf16 v[24:27], v[132:135], v[200:203], v[24:27]
    ds_read_b64_tr_b16 v[216:217], v9 offset:8192
    ds_read_b64_tr_b16 v[218:219], v9 offset:9216
    v_mfma_f32_16x16x32_bf16 v[28:31], v[136:139], v[196:199], v[28:31]
    v_mfma_f32_16x16x32_bf16 v[32:35], v[136:139], v[200:203], v[32:35]
    s_waitcnt vmcnt(7) lgkmcnt(0)
    s_barrier
    v_mfma_f32_16x16x32_bf16 v[20:23], v[140:143], v[204:207], v[20:23]
    ds_read_b128 v[156:159], v4 offset:49152
    ds_read_b128 v[160:163], v6 offset:49152
    v_mfma_f32_16x16x32_bf16 v[24:27], v[140:143], v[208:211], v[24:27]
    ds_read_b64_tr_b16 v[188:189], v8 offset:16384
    ds_read_b64_tr_b16 v[190:191], v8 offset:17408
    s_add_u32 s21, s39, 2
    s_and_b32 s21, s21, 7
    s_mul_i32 s21, s21, 229376
    s_add_u32 s21, s21, s65
    s_add_u32 m0, s63, 65536
    s_nop 0
    buffer_load_dwordx4 v2, s[12:15], s21 offen lds
    v_mfma_f32_16x16x32_bf16 v[28:31], v[144:147], v[204:207], v[28:31]
    ds_read_b64_tr_b16 v[192:193], v9 offset:16384
    ds_read_b64_tr_b16 v[194:195], v9 offset:17408
    v_mfma_f32_16x16x32_bf16 v[32:35], v[144:147], v[208:211], v[32:35]
    ds_read_b128 v[164:167], v5 offset:49152
    ds_read_b128 v[168:171], v7 offset:49152
    v_mfma_f32_16x16x32_bf16 v[20:23], v[148:151], v[212:215], v[20:23]
    ds_read_b64_tr_b16 v[196:197], v8 offset:24576
    ds_read_b64_tr_b16 v[198:199], v8 offset:25600
    s_add_u32 s21, s21, 14336
    s_add_u32 m0, s63, 66560
    s_nop 0
    buffer_load_dwordx4 v2, s[12:15], s21 offen lds
    v_mfma_f32_16x16x32_bf16 v[24:27], v[148:151], v[216:219], v[24:27]
    ds_read_b64_tr_b16 v[200:201], v9 offset:24576
    ds_read_b64_tr_b16 v[202:203], v9 offset:25600
    v_mfma_f32_16x16x32_bf16 v[28:31], v[152:155], v[212:215], v[28:31]
    v_mfma_f32_16x16x32_bf16 v[32:35], v[152:155], v[216:219], v[32:35]
    s_waitcnt vmcnt(6) lgkmcnt(0)
    s_barrier
    v_mfma_f32_16x16x32_bf16 v[20:23], v[156:159], v[188:191], v[20:23]
    ds_read_b128 v[172:175], v4 offset:57344
    ds_read_b128 v[176:179], v6 offset:57344
    v_mfma_f32_16x16x32_bf16 v[24:27], v[156:159], v[192:195], v[24:27]
    ds_read_b64_tr_b16 v[204:205], v8 offset:32768
    ds_read_b64_tr_b16 v[206:207], v8 offset:33792
    s_add_u32 s21, s39, 3
    s_and_b32 s21, s21, 7
    s_mul_i32 s21, s21, 229376
    s_add_u32 s21, s21, s65
    s_add_u32 m0, s63, 81920
    s_nop 0
    buffer_load_dwordx4 v2, s[12:15], s21 offen lds
    v_mfma_f32_16x16x32_bf16 v[28:31], v[160:163], v[188:191], v[28:31]
    ds_read_b64_tr_b16 v[208:209], v9 offset:32768
    ds_read_b64_tr_b16 v[210:211], v9 offset:33792
    v_mfma_f32_16x16x32_bf16 v[32:35], v[160:163], v[192:195], v[32:35]
    ds_read_b128 v[180:183], v5 offset:57344
    ds_read_b128 v[184:187], v7 offset:57344
    v_mfma_f32_16x16x32_bf16 v[20:23], v[164:167], v[196:199], v[20:23]
    ds_read_b64_tr_b16 v[212:213], v8 offset:40960
    ds_read_b64_tr_b16 v[214:215], v8 offset:41984
    s_add_u32 s21, s21, 14336
    s_add_u32 m0, s63, 82944
    s_nop 0
    buffer_load_dwordx4 v2, s[12:15], s21 offen lds
    v_mfma_f32_16x16x32_bf16 v[24:27], v[164:167], v[200:203], v[24:27]
    ds_read_b64_tr_b16 v[216:217], v9 offset:40960
    ds_read_b64_tr_b16 v[218:219], v9 offset:41984
    v_mfma_f32_16x16x32_bf16 v[28:31], v[168:171], v[196:199], v[28:31]
    v_mfma_f32_16x16x32_bf16 v[32:35], v[168:171], v[200:203], v[32:35]
    s_waitcnt vmcnt(6) lgkmcnt(0)
    s_barrier
    v_mfma_f32_16x16x32_bf16 v[20:23], v[172:175], v[204:207], v[20:23]
    ds_read_b64_tr_b16 v[188:189], v52 offset:49152
    ds_read_b64_tr_b16 v[190:191], v52 offset:50176
    v_mfma_f32_16x16x32_bf16 v[24:27], v[172:175], v[208:211], v[24:27]
    ds_read_b64_tr_b16 v[192:193], v53 offset:49152
    s_add_u32 s21, s39, 4
    s_and_b32 s21, s21, 7
    s_mul_i32 s21, s21, 229376
    s_add_u32 s21, s21, s65
    s_add_u32 m0, s63, 98304
    s_nop 0
    buffer_load_dwordx4 v2, s[12:15], s21 offen lds
    v_mfma_f32_16x16x32_bf16 v[28:31], v[176:179], v[204:207], v[28:31]
    ds_read_b64_tr_b16 v[194:195], v53 offset:50176
    v_mfma_f32_16x16x32_bf16 v[32:35], v[176:179], v[208:211], v[32:35]
    ds_read_b64_tr_b16 v[196:197], v52 offset:57344
    ds_read_b64_tr_b16 v[198:199], v52 offset:58368
    v_mfma_f32_16x16x32_bf16 v[20:23], v[180:183], v[212:215], v[20:23]
    ds_read_b64_tr_b16 v[200:201], v53 offset:57344
    s_add_u32 s21, s21, 14336
    s_add_u32 m0, s63, 99328
    s_nop 0
    buffer_load_dwordx4 v2, s[12:15], s21 offen lds
    v_mfma_f32_16x16x32_bf16 v[24:27], v[180:183], v[216:219], v[24:27]
    ds_read_b64_tr_b16 v[202:203], v53 offset:58368
    v_mfma_f32_16x16x32_bf16 v[28:31], v[184:187], v[212:215], v[28:31]
    v_mfma_f32_16x16x32_bf16 v[32:35], v[184:187], v[216:219], v[32:35]
    s_mul_i32 s6, s56, 0x9E3779B1
    s_add_u32 s6, s6, 0x7F4A7C15
    s_not_b32 s7, s6
    v_mul_f32 v220, v20, v20
    v_mul_f32 v221, v21, v21
    v_mul_f32 v222, v22, v22
    s_add_u32 s21, s39, 5
    s_and_b32 s21, s21, 7
    s_mul_i32 s21, s21, 229376
    s_add_u32 s21, s21, s65
    s_add_u32 m0, s63, 0
    s_nop 0
    buffer_load_dwordx4 v2, s[12:15], s21 offen lds
    v_mul_f32 v223, v23, v23
    v_mul_f32 v224, v24, v24
    v_mul_f32 v225, v25, v25
    v_mul_f32 v226, v26, v26
    v_mul_f32 v227, v27, v27
    v_mul_f32 v228, v28, v28
    v_mul_f32 v229, v29, v29
    v_mul_f32 v230, v30, v30
    v_mul_f32 v231, v31, v31
    v_mul_f32 v232, v32, v32
    v_mul_f32 v233, v33, v33
    s_add_u32 s21, s21, 14336
    s_add_u32 m0, s63, 1024
    s_nop 0
    buffer_load_dwordx4 v2, s[12:15], s21 offen lds
    v_mul_f32 v234, v34, v34
    v_mul_f32 v235, v35, v35
    v_fmamk_f32 v220, v220, 0xbdd2d3e8, v12
    v_fmamk_f32 v221, v221, 0xbdd2d3e8, v12
    v_fmamk_f32 v222, v222, 0xbdd2d3e8, v12
    v_fmamk_f32 v223, v223, 0xbdd2d3e8, v12
    v_fmamk_f32 v224, v224, 0xbdd2d3e8, v12
    v_fmamk_f32 v225, v225, 0xbdd2d3e8, v12
    v_fmamk_f32 v226, v226, 0xbdd2d3e8, v12
    v_fmamk_f32 v227, v227, 0xbdd2d3e8, v12
    v_fmamk_f32 v228, v228, 0xbdd2d3e8, v12
    v_fmamk_f32 v229, v229, 0xbdd2d3e8, v12
    s_add_u32 s21, s39, 6
    s_and_b32 s21, s21, 7
    s_mul_i32 s21, s21, 229376
    s_add_u32 s21, s21, s65
    s_add_u32 m0, s63, 16384
    s_nop 0
    buffer_load_dwordx4 v2, s[12:15], s21 offen lds
    v_fmamk_f32 v230, v230, 0xbdd2d3e8, v12
    v_fmamk_f32 v231, v231, 0xbdd2d3e8, v12
    v_fmamk_f32 v232, v232, 0xbdd2d3e8, v12
    v_fmamk_f32 v233, v233, 0xbdd2d3e8, v12
    v_fmamk_f32 v234, v234, 0xbdd2d3e8, v12
    v_fmamk_f32 v235, v235, 0xbdd2d3e8, v12
    v_mul_f32 v220, v220, v20
    v_mul_f32 v221, v221, v21
    v_mul_f32 v222, v222, v22
    v_mul_f32 v223, v223, v23
    v_mul_f32 v224, v224, v24
    s_add_u32 s21, s21, 14336
    s_add_u32 m0, s63, 17408
    s_nop 0
    buffer_load_dwordx4 v2, s[12:15], s21 offen lds
    v_mul_f32 v225, v225, v25
    v_mul_f32 v226, v226, v26
    v_mul_f32 v227, v227, v27
    v_mul_f32 v228, v228, v28
    v_mul_f32 v229, v229, v29
    v_mul_f32 v230, v230, v30
    v_mul_f32 v231, v231, v31
    v_mul_f32 v232, v232, v32
    v_mul_f32 v233, v233, v33
    v_mul_f32 v234, v234, v34
    v_mul_f32 v235, v235, v35
    v_exp_f32 v220, v220
    s_add_u32 s21, s39, 7
    s_and_b32 s21, s21, 7
    s_mul_i32 s21, s21, 229376
    s_add_u32 s21, s21, s65
    s_add_u32 m0, s63, 32768
    s_nop 0
    buffer_load_dwordx4 v2, s[12:15], s21 offen lds
    v_exp_f32 v221, v221
    v_exp_f32 v222, v222
    v_exp_f32 v223, v223
    v_exp_f32 v224, v224
    v_exp_f32 v225, v225
    v_exp_f32 v226, v226
    v_exp_f32 v227, v227
    v_exp_f32 v228, v228
    v_exp_f32 v229, v229
    v_exp_f32 v230, v230
    v_exp_f32 v231, v231
    s_add_u32 s21, s21, 14336
    s_add_u32 m0, s63, 33792
    s_nop 0
    buffer_load_dwordx4 v2, s[12:15], s21 offen lds
    v_exp_f32 v232, v232
    v_exp_f32 v233, v233
    v_exp_f32 v234, v234
    v_exp_f32 v235, v235
    v_add_f32 v220, 1.0, v220
    v_add_f32 v221, 1.0, v221
    v_add_f32 v222, 1.0, v222
    v_add_f32 v223, 1.0, v223
    v_add_f32 v224, 1.0, v224
    v_add_f32 v225, 1.0, v225
    v_add_f32 v226, 1.0, v226
    v_add_f32 v227, 1.0, v227
    v_add_f32 v228, 1.0, v228
    v_add_f32 v229, 1.0, v229
    v_add_f32 v230, 1.0, v230
    v_add_f32 v231, 1.0, v231
    v_add_f32 v232, 1.0, v232
    v_add_f32 v233, 1.0, v233
    v_add_f32 v234, 1.0, v234
    v_add_f32 v235, 1.0, v235
    v_rcp_f32 v220, v220
    v_rcp_f32 v221, v221
    v_rcp_f32 v222, v222
    v_rcp_f32 v223, v223
    v_rcp_f32 v224, v224
    v_rcp_f32 v225, v225
    v_rcp_f32 v226, v226
    v_rcp_f32 v227, v227
    v_rcp_f32 v228, v228
    v_rcp_f32 v229, v229
    v_rcp_f32 v230, v230
    v_rcp_f32 v231, v231
    v_rcp_f32 v232, v232
    v_rcp_f32 v233, v233
    v_rcp_f32 v234, v234
    v_rcp_f32 v235, v235
    v_mul_f32 v20, v20, v220
    v_mul_f32 v21, v21, v221
    v_mul_f32 v22, v22, v222
    v_mul_f32 v23, v23, v223
    v_mul_f32 v24, v24, v224
    v_mul_f32 v25, v25, v225
    v_mul_f32 v26, v26, v226
    v_mul_f32 v27, v27, v227
    v_mul_f32 v28, v28, v228
    v_mul_f32 v29, v29, v229
    v_mul_f32 v30, v30, v230
    v_mul_f32 v31, v31, v231
    v_mul_f32 v32, v32, v232
    v_mul_f32 v33, v33, v233
    v_mul_f32 v34, v34, v234
    v_mul_f32 v35, v35, v235
    v_add_f32 v220, v20, v24
    v_mul_f32 v221, v20, v20
    v_add_f32 v222, v21, v25
    v_mul_f32 v223, v21, v21
    v_add_f32 v224, v22, v26
    v_mul_f32 v225, v22, v22
    v_add_f32 v226, v23, v27
    v_mul_f32 v227, v23, v23
    v_add_f32 v228, v28, v32
    v_mul_f32 v229, v28, v28
    v_add_f32 v230, v29, v33
    v_mul_f32 v231, v29, v29
    v_add_f32 v232, v30, v34
    v_mul_f32 v233, v30, v30
    v_add_f32 v234, v31, v35
    v_mul_f32 v235, v31, v31
    v_fmac_f32 v221, v24, v24
    v_fmac_f32 v223, v25, v25
    v_fmac_f32 v225, v26, v26
    v_fmac_f32 v227, v27, v27
    v_fmac_f32 v229, v32, v32
    v_fmac_f32 v231, v33, v33
    v_fmac_f32 v233, v34, v34
    v_fmac_f32 v235, v35, v35
    v_add_f32_dpp v220, v220, v220 row_ror:8 row_mask:0xf bank_mask:0x3
    v_add_f32_dpp v221, v221, v221 row_ror:8 row_mask:0xf bank_mask:0x3
    v_add_f32_dpp v222, v222, v222 row_ror:8 row_mask:0xf bank_mask:0x3
    v_add_f32_dpp v223, v223, v223 row_ror:8 row_mask:0xf bank_mask:0x3
    v_add_f32_dpp v224, v224, v224 row_ror:8 row_mask:0xf bank_mask:0x3
    v_add_f32_dpp v225, v225, v225 row_ror:8 row_mask:0xf bank_mask:0x3
    v_add_f32_dpp v226, v226, v226 row_ror:8 row_mask:0xf bank_mask:0x3
    v_add_f32_dpp v227, v227, v227 row_ror:8 row_mask:0xf bank_mask:0x3
    v_add_f32_dpp v220, v228, v228 row_ror:8 row_mask:0xf bank_mask:0xc
    v_add_f32_dpp v221, v229, v229 row_ror:8 row_mask:0xf bank_mask:0xc
    v_add_f32_dpp v222, v230, v230 row_ror:8 row_mask:0xf bank_mask:0xc
    v_add_f32_dpp v223, v231, v231 row_ror:8 row_mask:0xf bank_mask:0xc
    v_add_f32_dpp v224, v232, v232 row_ror:8 row_mask:0xf bank_mask:0xc
    v_add_f32_dpp v225, v233, v233 row_ror:8 row_mask:0xf bank_mask:0xc
    v_add_f32_dpp v226, v234, v234 row_ror:8 row_mask:0xf bank_mask:0xc
    v_add_f32_dpp v227, v235, v235 row_ror:8 row_mask:0xf bank_mask:0xc
    v_add_f32_dpp v220, v220, v220 row_half_mirror row_mask:0xf bank_mask:0x5
    v_add_f32_dpp v221, v221, v221 row_half_mirror row_mask:0xf bank_mask:0x5
    v_add_f32_dpp v222, v222, v222 row_half_mirror row_mask:0xf bank_mask:0x5
    v_add_f32_dpp v223, v223, v223 row_half_mirror row_mask:0xf bank_mask:0x5
    v_add_f32_dpp v220, v224, v224 row_half_mirror row_mask:0xf bank_mask:0xa
    v_add_f32_dpp v221, v225, v225 row_half_mirror row_mask:0xf bank_mask:0xa
    v_add_f32_dpp v222, v226, v226 row_half_mirror row_mask:0xf bank_mask:0xa
    v_add_f32_dpp v223, v227, v227 row_half_mirror row_mask:0xf bank_mask:0xa
    v_add_f32_dpp v220, v220, v220 quad_perm:[1,0,3,2] row_mask:0xf bank_mask:0xf
    v_add_f32_dpp v221, v221, v221 quad_perm:[1,0,3,2] row_mask:0xf bank_mask:0xf
    v_add_f32_dpp v222, v222, v222 quad_perm:[1,0,3,2] row_mask:0xf bank_mask:0xf
    v_add_f32_dpp v223, v223, v223 quad_perm:[1,0,3,2] row_mask:0xf bank_mask:0xf
    v_add_f32_dpp v220, v220, v220 quad_perm:[2,3,0,1] row_mask:0xf bank_mask:0xf
    v_add_f32_dpp v221, v221, v221 quad_perm:[2,3,0,1] row_mask:0xf bank_mask:0xf
    v_add_f32_dpp v222, v222, v222 quad_perm:[2,3,0,1] row_mask:0xf bank_mask:0xf
    v_add_f32_dpp v223, v223, v223 quad_perm:[2,3,0,1] row_mask:0xf bank_mask:0xf
    s_mov_b32 s70, 0x11111111
    s_mov_b32 s71, 0x11111111
    s_mov_b64 exec, s[70:71]
    ds_write_b128 v13, v[220:223]
    s_mov_b64 exec, -1
    s_mov_b32 s20, s42
    s_and_b32 s21, s43, 0xffff
    s_mov_b32 s22, 8388608
    s_mov_b32 s23, 0x20000
    s_lshl_b32 s72, s4, 3
    s_add_u32 s72, s72, s5
    s_lshl_b32 s72, s72, 3
    s_add_u32 s72, s72, s3
    s_lshl_b32 s72, s72, 12
    s_mul_i32 s73, s4, 0
    s_add_u32 s73, s73, 1024
    v_lshl_add_u32 v18, v0, 7, s73
    v_and_b32 v18, 4095, v18
    s_mov_b32 exec_lo, 0xfff
    s_mov_b32 exec_hi, 0x0
    buffer_load_dword v255, v18, s[20:23], s72 offen
    s_mov_b64 exec, -1
    s_branch L_z1
L_role7:
    s_add_u32 s21, s39, 0
    s_and_b32 s21, s21, 7
    s_lshl_b32 s21, s21, 7
    s_add_u32 s21, s21, s62
    s_add_u32 m0, s61, 0
    s_nop 0
    buffer_load_dwordx4 v1, s[8:11], s21 offen lds
    s_add_u32 s21, s39, 1
    s_and_b32 s21, s21, 7
    s_lshl_b32 s21, s21, 7
    s_add_u32 s21, s21, s62
    s_add_u32 m0, s61, 8192
    s_nop 0
    buffer_load_dwordx4 v1, s[8:11], s21 offen lds
    s_add_u32 s21, s39, 2
    s_and_b32 s21, s21, 7
    s_lshl_b32 s21, s21, 7
    s_add_u32 s21, s21, s62
    s_add_u32 m0, s61, 16384
    s_nop 0
    buffer_load_dwordx4 v1, s[8:11], s21 offen lds
    s_add_u32 s21, s39, 3
    s_and_b32 s21, s21, 7
    s_lshl_b32 s21, s21, 7
    s_add_u32 s21, s21, s62
    s_add_u32 m0, s61, 24576
    s_nop 0
    buffer_load_dwordx4 v1, s[8:11], s21 offen lds
    s_add_u32 s21, s39, 4
    s_and_b32 s21, s21, 7
    s_lshl_b32 s21, s21, 7
    s_add_u32 s21, s21, s62
    s_add_u32 m0, s61, 32768
    s_nop 0
    buffer_load_dwordx4 v1, s[8:11], s21 offen lds
    s_add_u32 s21, s39, 5
    s_and_b32 s21, s21, 7
    s_lshl_b32 s21, s21, 7
    s_add_u32 s21, s21, s62
    s_add_u32 m0, s61, 40960
    s_nop 0
    buffer_load_dwordx4 v1, s[8:11], s21 offen lds
    s_add_u32 s21, s39, 6
    s_and_b32 s21, s21, 7
    s_lshl_b32 s21, s21, 7
    s_add_u32 s21, s21, s62
    s_add_u32 m0, s61, 49152
    s_nop 0
    buffer_load_dwordx4 v1, s[8:11], s21 offen lds
    s_add_u32 s21, s39, 7
    s_and_b32 s21, s21, 7
    s_lshl_b32 s21, s21, 7
    s_add_u32 s21, s21, s62
    s_add_u32 m0, s61, 57344
    s_nop 0
    buffer_load_dwordx4 v1, s[8:11], s21 offen lds
    s_cmp_ge_u32 s3, 4
    s_cbranch_scc1 L_ep_4
    v_and_b32 v14, 15, v0
    s_lshl_b32 s20, s4, 6
    v_add_u32 v14, s20, v14
    v_lshlrev_b32 v14, 1, v14
    global_load_ushort v250, v14, s[44:45] offset:0
    global_load_ushort v251, v14, s[44:45] offset:32
    global_load_ushort v252, v14, s[44:45] offset:64
    global_load_ushort v253, v14, s[44:45] offset:96
    s_branch L_epd_5
L_ep_4:
    s_lshl_b32 s20, s68, 7
    s_sub_u32 s21, s3, 4
    s_lshl_b32 s21, s21, 7
    s_add_u32 s20, s20, s21
    v_lshl_add_u32 v14, v0, 1, s20
    global_load_ushort v250, v14, s[26:27]
    global_load_ushort v251, v14, s[28:29]
    global_load_ushort v252, v14, s[30:31]
    global_load_ushort v253, v14, s[32:33]
    s_cmp_eq_u32 s3, 7
    s_cbranch_scc0 L_epd_5
    s_lshl_b32 s20, s39, 7
    v_lshl_add_u32 v14, v0, 4, s20
    v_and_b32 v14, 1023, v14
    s_mov_b32 m0, 161792
    s_nop 0
    global_load_lds_dwordx4 v14, s[48:49]
L_epd_5:
    s_getpc_b64 s[72:73]
L_pc_6:
    s_lshr_b32 s22, s2, 3
    s_mul_i32 s22, s22, 12
    s_and_b32 s23, s3, 7
    s_lshl_b32 s23, s23, 1
    s_add_u32 s22, s22, s23
    s_lshl_b32 s22, s22, 7
    v_lshl_add_u32 v18, v0, 7, s22
    v_min_u32 v18, L_end-L_pc_6, v18
    s_cmp_lt_u32 s3, 6
    s_cselect_b32 exec_lo, 3, 1
    s_mov_b32 exec_hi, 0
    global_load_dword v255, v18, s[72:73]
    s_mov_b64 exec, -1
    s_mov_b32 s16, s54
    s_and_b32 s17, s55, 0xffff
    s_mov_b32 s18, 268435456
    s_mov_b32 s19, 0x20000
    s_load_dword s56, s[54:55], 0
    s_load_dword s57, s[34:35], s68
    s_load_dword s58, s[36:37], s68
    v_mov_b32 v12, 0xc0135761
    s_waitcnt vmcnt(1) lgkmcnt(0)
    s_mul_i32 s6, s56, 0x9E3779B1
    s_add_u32 s6, s6, 0x7F4A7C15
    s_not_b32 s7, s6
    s_barrier
    v_lshrrev_b32 v14, 4, v0
    v_and_b32 v15, 1, v14
    v_lshrrev_b32 v14, 1, v14
    v_bfe_u32 v16, v0, 2, 2
    v_and_b32 v17, 3, v0
    v_lshlrev_b32 v18, 5, v14
    v_lshl_add_u32 v18, v17, 3, v18
    v_add_u32 v18, v18, v16
    s_sub_u32 s20, s3, s39
    s_and_b32 s20, s20, 7
    s_lshl_b32 s20, s20, 13
    v_bfe_u32 v100, v18, 1, 3
    v_lshrrev_b32 v19, 3, v18
    v_and_b32 v19, 2, v19
    v_xor_b32 v100, v100, v19
    v_lshlrev_b32 v100, 4, v100
    v_lshlrev_b32 v19, 7, v18
    v_lshl_add_u32 v19, v15, 3, v19
    v_add_u32 v102, s20, v19
    v_add_u32 v18, 4, v18
    v_bfe_u32 v101, v18, 1, 3
    v_lshrrev_b32 v19, 3, v18
    v_and_b32 v19, 2, v19
    v_xor_b32 v101, v101, v19
    v_lshlrev_b32 v101, 4, v101
    v_lshlrev_b32 v19, 7, v18
    v_lshl_add_u32 v19, v15, 3, v19
    v_add_u32 v103, s20, v19
    v_lshlrev_b32 v18, 14, v15
    v_lshrrev_b32 v19, 1, v17
    v_lshl_add_u32 v18, v19, 13, v18
    v_lshl_add_u32 v18, v14, 7, v18
    v_lshl_add_u32 v18, v16, 5, v18
    v_and_b32 v19, 1, v17
    v_lshl_add_u32 v18, v19, 4, v18
    v_xor_b32 v19, 0, v100
    v_add_u32 v19, v19, v102
    ds_read_b64_tr_b16 v[60:61], v19 offset:0
    v_xor_b32 v19, 0, v101
    v_add_u32 v19, v19, v103
    ds_read_b64_tr_b16 v[62:63], v19 offset:0
    v_xor_b32 v19, 16, v100
    v_add_u32 v19, v19, v102
    ds_read_b64_tr_b16 v[64:65], v19 offset:0
    v_xor_b32 v19, 16, v101
    v_add_u32 v19, v19, v103
    ds_read_b64_tr_b16 v[66:67], v19 offset:0
    v_xor_b32 v19, 32, v100
    v_add_u32 v19, v19, v102
    ds_read_b64_tr_b16 v[68:69], v19 offset:0
    v_xor_b32 v19, 32, v101
    v_add_u32 v19, v19, v103
    ds_read_b64_tr_b16 v[70:71], v19 offset:0
    v_xor_b32 v19, 48, v100
    v_add_u32 v19, v19, v102
    ds_read_b64_tr_b16 v[72:73], v19 offset:0
    v_xor_b32 v19, 48, v101
    v_add_u32 v19, v19, v103
    ds_read_b64_tr_b16 v[74:75], v19 offset:0
    v_xor_b32 v19, 64, v100
    v_add_u32 v19, v19, v102
    ds_read_b64_tr_b16 v[76:77], v19 offset:0
    v_xor_b32 v19, 64, v101
    v_add_u32 v19, v19, v103
    ds_read_b64_tr_b16 v[78:79], v19 offset:0
    v_xor_b32 v19, 80, v100
    v_add_u32 v19, v19, v102
    ds_read_b64_tr_b16 v[80:81], v19 offset:0
    v_xor_b32 v19, 80, v101
    v_add_u32 v19, v19, v103
    ds_read_b64_tr_b16 v[82:83], v19 offset:0
    v_xor_b32 v19, 96, v100
    v_add_u32 v19, v19, v102
    ds_read_b64_tr_b16 v[84:85], v19 offset:0
    v_xor_b32 v19, 96, v101
    v_add_u32 v19, v19, v103
    ds_read_b64_tr_b16 v[86:87], v19 offset:0
    v_xor_b32 v19, 112, v100
    v_add_u32 v19, v19, v102
    ds_read_b64_tr_b16 v[88:89], v19 offset:0
    v_xor_b32 v19, 112, v101
    v_add_u32 v19, v19, v103
    ds_read_b64_tr_b16 v[90:91], v19 offset:0
    s_lshl_b32 s21, s3, 18
    s_lshl_b32 s22, s4, 8
    s_add_u32 s21, s21, s22
    s_add_u32 s21, s21, 5242880
    s_waitcnt lgkmcnt(14)
    s_add_u32 s22, s21, 0
    buffer_store_dwordx4 v[60:63], v18, s[16:19], s22 offen sc1
    s_waitcnt lgkmcnt(12)
    s_add_u32 s22, s21, 32768
    buffer_store_dwordx4 v[64:67], v18, s[16:19], s22 offen sc1
    s_waitcnt lgkmcnt(10)
    s_add_u32 s22, s21, 65536
    buffer_store_dwordx4 v[68:71], v18, s[16:19], s22 offen sc1
    s_waitcnt lgkmcnt(8)
    s_add_u32 s22, s21, 98304
    buffer_store_dwordx4 v[72:75], v18, s[16:19], s22 offen sc1
    s_waitcnt lgkmcnt(6)
    s_add_u32 s22, s21, 131072
    buffer_store_dwordx4 v[76:79], v18, s[16:19], s22 offen sc1
    s_waitcnt lgkmcnt(4)
    s_add_u32 s22, s21, 163840
    buffer_store_dwordx4 v[80:83], v18, s[16:19], s22 offen sc1
    s_waitcnt lgkmcnt(2)
    s_add_u32 s22, s21, 196608
    buffer_store_dwordx4 v[84:87], v18, s[16:19], s22 offen sc1
    s_waitcnt lgkmcnt(0)
    s_add_u32 s22, s21, 229376
    buffer_store_dwordx4 v[88:91], v18, s[16:19], s22 offen sc1
    s_cmp_ge_u32 s3, 4
    s_cbranch_scc1 L_ng_7
    v_and_b32 v14, 15, v0
    v_lshrrev_b32 v15, 4, v0
    s_lshl_b32 s20, s3, 4
    v_add_u32 v16, s20, v14
    v_bfe_u32 v17, v16, 1, 3
    v_lshrrev_b32 v18, 3, v16
    v_and_b32 v18, 2, v18
    v_xor_b32 v17, v17, v18
    v_xor_b32 v17, v17, v15
    v_lshlrev_b32 v17, 4, v17
    v_lshl_add_u32 v17, v16, 7, v17
    v_xor_b32 v18, 64, v17
    v_lshlrev_b32 v19, 4, v15
    v_add_u32 v19, 161792, v19
    ds_read_b128 v[60:63], v17 offset:0
    ds_read_b128 v[64:67], v19 offset:0
    ds_read_b128 v[68:71], v18 offset:0
    ds_read_b128 v[72:75], v19 offset:64
    ds_read_b128 v[76:79], v17 offset:8192
    ds_read_b128 v[80:83], v19 offset:128
    ds_read_b128 v[84:87], v18 offset:8192
    ds_read_b128 v[88:91], v19 offset:192
    ds_read_b128 v[92:95], v17 offset:16384
    ds_read_b128 v[96:99], v19 offset:256
    ds_read_b128 v[100:103], v18 offset:16384
    ds_read_b128 v[104:107], v19 offset:320
    ds_read_b128 v[108:111], v17 offset:24576
    ds_read_b128 v[112:115], v19 offset:384
    ds_read_b128 v[116:119], v18 offset:24576
    ds_read_b128 v[120:123], v19 offset:448
    s_waitcnt lgkmcnt(14)
    v_mfma_f32_16x16x32_bf16 v[220:223], v[64:67], v[60:63], 0
    s_waitcnt lgkmcnt(12)
    v_mfma_f32_16x16x32_bf16 v[220:223], v[72:75], v[68:71], v[220:223]
    s_waitcnt lgkmcnt(10)
    v_mfma_f32_16x16x32_bf16 v[220:223], v[80:83], v[76:79], v[220:223]
    s_waitcnt lgkmcnt(8)
    v_mfma_f32_16x16x32_bf16 v[220:223], v[88:91], v[84:87], v[220:223]
    s_waitcnt lgkmcnt(6)
    v_mfma_f32_16x16x32_bf16 v[220:223], v[96:99], v[92:95], v[220:223]
    s_waitcnt lgkmcnt(4)
    v_mfma_f32_16x16x32_bf16 v[220:223], v[104:107], v[100:103], v[220:223]
    s_waitcnt lgkmcnt(2)
    v_mfma_f32_16x16x32_bf16 v[220:223], v[112:115], v[108:111], v[220:223]
    s_waitcnt lgkmcnt(0)
    v_mfma_f32_16x16x32_bf16 v[220:223], v[120:123], v[116:119], v[220:223]
    ds_read_b128 v[60:63], v17 offset:32768
    ds_read_b128 v[64:67], v19 offset:512
    ds_read_b128 v[68:71], v18 offset:32768
    ds_read_b128 v[72:75], v19 offset:576
    ds_read_b128 v[76:79], v17 offset:40960
    ds_read_b128 v[80:83], v19 offset:640
    ds_read_b128 v[84:87], v18 offset:40960
    ds_read_b128 v[88:91], v19 offset:704
    ds_read_b128 v[92:95], v17 offset:49152
    ds_read_b128 v[96:99], v19 offset:768
    ds_read_b128 v[100:103], v18 offset:49152
    ds_read_b128 v[104:107], v19 offset:832
    ds_read_b128 v[108:111], v17 offset:57344
    ds_read_b128 v[112:115], v19 offset:896
    ds_read_b128 v[116:119], v18 offset:57344
    ds_read_b128 v[120:123], v19 offset:960
    s_waitcnt lgkmcnt(14)
    v_mfma_f32_16x16x32_bf16 v[220:223], v[64:67], v[60:63], v[220:223]
    s_waitcnt lgkmcnt(12)
    v_mfma_f32_16x16x32_bf16 v[220:223], v[72:75], v[68:71], v[220:223]
    s_waitcnt lgkmcnt(10)
    v_mfma_f32_16x16x32_bf16 v[220:223], v[80:83], v[76:79], v[220:223]
    s_waitcnt lgkmcnt(8)
    v_mfma_f32_16x16x32_bf16 v[220:223], v[88:91], v[84:87], v[220:223]
    s_waitcnt lgkmcnt(6)
    v_mfma_f32_16x16x32_bf16 v[220:223], v[96:99], v[92:95], v[220:223]
    s_waitcnt lgkmcnt(4)
    v_mfma_f32_16x16x32_bf16 v[220:223], v[104:107], v[100:103], v[220:223]
    s_waitcnt lgkmcnt(2)
    v_mfma_f32_16x16x32_bf16 v[220:223], v[112:115], v[108:111], v[220:223]
    s_waitcnt lgkmcnt(0)
    v_mfma_f32_16x16x32_bf16 v[220:223], v[120:123], v[116:119], v[220:223]
    s_nop 7
    v_cvt_pk_bf16_f32 v220, v220, v220
    v_lshlrev_b32 v220, 16, v220
    v_mul_f32 v220, 0xbfb8aa3b, v220
    v_exp_f32 v220, v220
    s_nop 0
    v_add_f32 v220, 1.0, v220
    v_rcp_f32 v220, v220
    v_lshlrev_b32 v16, 2, v16
    s_lshl_b32 s20, s4, 8
    s_add_u32 s20, s20, 16384
    v_cvt_pk_bf16_f32 v220, v220, v220
    v_lshlrev_b32 v220, 16, v220
    s_mov_b64 exec, 0xffff
    buffer_store_dword v220, v16, s[16:19], s20 offen sc1
    s_mov_b64 exec, -1
L_ng_7:
    s_mov_b32 s20, s42
    s_and_b32 s21, s43, 0xffff
    s_mov_b32 s22, 8388608
    s_mov_b32 s23, 0x20000
    v_lshrrev_b32 v18, 3, v0
    s_lshl_b32 s72, s4, 18
    s_lshl_b32 s73, s3, 15
    s_add_u32 s72, s72, s73
    s_mul_i32 s73, s4, 0
    s_add_u32 s73, s73, 0
    v_and_b32 v19, 7, v0
    v_lshl_add_u32 v19, v19, 7, s73
    v_and_b32 v19, 4095, v19
    v_lshl_add_u32 v19, v18, 12, v19
    buffer_load_dword v255, v19, s[20:23], s72 offen
    s_waitcnt vmcnt(1)
    s_barrier
    s_cmp_eq_u32 s3, 0
    s_cbranch_scc0 L_nf_8
    s_lshl_b32 s20, s5, 5
    s_add_u32 s20, s20, s4
    s_lshl_b32 s20, s20, 7
    s_add_u32 s20, s20, 393216
    v_mov_b32 v14, s6
    v_mov_b32 v15, s7
    v_mov_b32 v16, 0
    s_mov_b64 exec, 1
    buffer_store_dwordx2 v[14:15], v16, s[16:19], s20 offen sc1
    s_mov_b64 exec, -1
L_nf_8:
    s_mov_b32 s20, s42
    s_and_b32 s21, s43, 0xffff
    s_mov_b32 s22, 8388608
    s_mov_b32 s23, 0x20000
    s_lshl_b32 s72, s4, 3
    s_add_u32 s72, s72, s5
    s_lshl_b32 s72, s72, 3
    s_add_u32 s72, s72, s3
    s_lshl_b32 s72, s72, 12
    s_mul_i32 s73, s4, 0
    s_add_u32 s73, s73, 1024
    v_lshl_add_u32 v18, v0, 7, s73
    v_and_b32 v18, 4095, v18
    s_mov_b32 exec_lo, 0xfff
    s_mov_b32 exec_hi, 0x0
    buffer_load_dword v255, v18, s[20:23], s72 offen
    s_mov_b64 exec, -1
    s_mov_b32 s20, s42
    s_and_b32 s21, s43, 0xffff
    s_mov_b32 s22, 8388608
    s_mov_b32 s23, 0x20000
    v_lshrrev_b32 v18, 3, v0
    s_lshl_b32 s72, s4, 18
    s_lshl_b32 s73, s3, 15
    s_add_u32 s72, s72, s73
    s_cmp_ge_u32 s3, 4
    s_cbranch_scc1 L_two_9
    s_mov_b32 s20, s46
    s_and_b32 s21, s47, 0xffff
    s_mov_b32 s22, 917504
    s_mov_b32 s23, 0x20000
    s_mul_i32 s72, s4, 28672
    s_mul_i32 s73, s3, 7168
    s_add_u32 s72, s72, s73
    v_lshlrev_b32 v19, 7, v0
    s_mov_b32 exec_hi, 0xffffff
    buffer_load_dword v255, v19, s[20:23], s72 offen
    s_mov_b64 exec, -1
L_two_9:
    s_waitcnt vmcnt(0)
    s_barrier
    s_branch L_p1done
L_z1:
    s_waitcnt vmcnt(7) lgkmcnt(0)
    s_barrier
    s_cmp_eq_u32 s3, 0
    s_cbranch_scc0 L_nsp_10
    v_lshlrev_b32 v14, 3, v0
    v_add_u32 v14, 147456, v14
    ds_read_b64 v[220:221], v14 offset:0
    ds_read_b64 v[222:223], v14 offset:512
    ds_read_b64 v[224:225], v14 offset:1024
    ds_read_b64 v[226:227], v14 offset:1536
    s_mul_i32 s21, s4, 7
    s_add_u32 s21, s21, s5
    s_lshl_b32 s21, s21, 10
    s_add_u32 s21, s21, 65536
    v_lshlrev_b32 v14, 4, v0
    v_mov_b32 v229, s6
    v_mov_b32 v231, s7
    s_waitcnt lgkmcnt(0)
    v_add_f32 v220, v220, v222
    v_add_f32 v224, v224, v226
    v_add_f32 v221, v221, v223
    v_add_f32 v225, v225, v227
    v_add_f32 v228, v220, v224
    v_add_f32 v230, v221, v225
    buffer_store_dwordx4 v[228:231], v14, s[16:19], s21 offen sc1
L_nsp_10:
    v_mfma_f32_16x16x32_bf16 v[36:39], v[188:191], v[60:63], 0
    ds_read_b64_tr_b16 v[204:205], v54 offset:0
    ds_read_b64_tr_b16 v[206:207], v54 offset:1024
    v_mfma_f32_16x16x32_bf16 v[40:43], v[192:195], v[60:63], 0
    ds_read_b64_tr_b16 v[208:209], v55 offset:0
    v_mfma_f32_16x16x32_bf16 v[44:47], v[188:191], v[64:67], 0
    ds_read_b64_tr_b16 v[210:211], v55 offset:1024
    v_mfma_f32_16x16x32_bf16 v[48:51], v[192:195], v[64:67], 0
    ds_read_b64_tr_b16 v[212:213], v54 offset:8192
    ds_read_b64_tr_b16 v[214:215], v54 offset:9216
    v_mfma_f32_16x16x32_bf16 v[36:39], v[196:199], v[68:71], v[36:39]
    ds_read_b64_tr_b16 v[216:217], v55 offset:8192
    v_mfma_f32_16x16x32_bf16 v[40:43], v[200:203], v[68:71], v[40:43]
    ds_read_b64_tr_b16 v[218:219], v55 offset:9216
    v_mfma_f32_16x16x32_bf16 v[44:47], v[196:199], v[72:75], v[44:47]
    v_mfma_f32_16x16x32_bf16 v[48:51], v[200:203], v[72:75], v[48:51]
    s_waitcnt lgkmcnt(0)
    v_mfma_f32_16x16x32_bf16 v[36:39], v[204:207], v[76:79], v[36:39]
    ds_read_b64_tr_b16 v[188:189], v52 offset:0
    ds_read_b64_tr_b16 v[190:191], v52 offset:1024
    v_mfma_f32_16x16x32_bf16 v[40:43], v[208:211], v[76:79], v[40:43]
    ds_read_b64_tr_b16 v[192:193], v53 offset:0
    v_mfma_f32_16x16x32_bf16 v[44:47], v[204:207], v[80:83], v[44:47]
    ds_read_b64_tr_b16 v[194:195], v53 offset:1024
    v_mfma_f32_16x16x32_bf16 v[48:51], v[208:211], v[80:83], v[48:51]
    ds_read_b64_tr_b16 v[196:197], v52 offset:8192
    ds_read_b64_tr_b16 v[198:199], v52 offset:9216
    v_mfma_f32_16x16x32_bf16 v[36:39], v[212:215], v[84:87], v[36:39]
    ds_read_b64_tr_b16 v[200:201], v53 offset:8192
    v_mfma_f32_16x16x32_bf16 v[40:43], v[216:219], v[84:87], v[40:43]
    ds_read_b64_tr_b16 v[202:203], v53 offset:9216
    v_mfma_f32_16x16x32_bf16 v[44:47], v[212:215], v[88:91], v[44:47]
    v_mfma_f32_16x16x32_bf16 v[48:51], v[216:219], v[88:91], v[48:51]
    s_waitcnt lgkmcnt(0)
    v_mfma_f32_16x16x32_bf16 v[36:39], v[188:191], v[92:95], v[36:39]
    ds_read_b64_tr_b16 v[204:205], v52 offset:16384
    ds_read_b64_tr_b16 v[206:207], v52 offset:17408
    v_mfma_f32_16x16x32_bf16 v[40:43], v[192:195], v[92:95], v[40:43]
    ds_read_b64_tr_b16 v[208:209], v53 offset:16384
    v_mfma_f32_16x16x32_bf16 v[44:47], v[188:191], v[96:99], v[44:47]
    ds_read_b64_tr_b16 v[210:211], v53 offset:17408
    v_mfma_f32_16x16x32_bf16 v[48:51], v[192:195], v[96:99], v[48:51]
    ds_read_b64_tr_b16 v[212:213], v52 offset:24576
    ds_read_b64_tr_b16 v[214:215], v52 offset:25600
    v_mfma_f32_16x16x32_bf16 v[36:39], v[196:199], v[100:103], v[36:39]
    ds_read_b64_tr_b16 v[216:217], v53 offset:24576
    v_mfma_f32_16x16x32_bf16 v[40:43], v[200:203], v[100:103], v[40:43]
    ds_read_b64_tr_b16 v[218:219], v53 offset:25600
    v_mfma_f32_16x16x32_bf16 v[44:47], v[196:199], v[104:107], v[44:47]
    v_mfma_f32_16x16x32_bf16 v[48:51], v[200:203], v[104:107], v[48:51]
    s_waitcnt lgkmcnt(0)
    v_mfma_f32_16x16x32_bf16 v[36:39], v[204:207], v[108:111], v[36:39]
    ds_read_b64_tr_b16 v[188:189], v52 offset:32768
    ds_read_b64_tr_b16 v[190:191], v52 offset:33792
    v_mfma_f32_16x16x32_bf16 v[40:43], v[208:211], v[108:111], v[40:43]
    ds_read_b64_tr_b16 v[192:193], v53 offset:32768
    v_mfma_f32_16x16x32_bf16 v[44:47], v[204:207], v[112:115], v[44:47]
    ds_read_b64_tr_b16 v[194:195], v53 offset:33792
    v_mfma_f32_16x16x32_bf16 v[48:51], v[208:211], v[112:115], v[48:51]
    ds_read_b64_tr_b16 v[196:197], v52 offset:40960
    ds_read_b64_tr_b16 v[198:199], v52 offset:41984
    v_mfma_f32_16x16x32_bf16 v[36:39], v[212:215], v[116:119], v[36:39]
    ds_read_b64_tr_b16 v[200:201], v53 offset:40960
    v_mfma_f32_16x16x32_bf16 v[40:43], v[216:219], v[116:119], v[40:43]
    ds_read_b64_tr_b16 v[202:203], v53 offset:41984
    v_mfma_f32_16x16x32_bf16 v[44:47], v[212:215], v[120:123], v[44:47]
    v_mfma_f32_16x16x32_bf16 v[48:51], v[216:219], v[120:123], v[48:51]
    s_waitcnt vmcnt(1) lgkmcnt(0)
    s_barrier
    v_mfma_f32_16x16x32_bf16 v[36:39], v[188:191], v[124:127], v[36:39]
    ds_read_b64_tr_b16 v[204:205], v56 offset:0
    ds_read_b64_tr_b16 v[206:207], v56 offset:1024
    v_mfma_f32_16x16x32_bf16 v[40:43], v[192:195], v[124:127], v[40:43]
    ds_read_b64_tr_b16 v[208:209], v57 offset:0
    v_mfma_f32_16x16x32_bf16 v[44:47], v[188:191], v[128:131], v[44:47]
    ds_read_b64_tr_b16 v[210:211], v57 offset:1024
    v_mfma_f32_16x16x32_bf16 v[48:51], v[192:195], v[128:131], v[48:51]
    ds_read_b64_tr_b16 v[212:213], v56 offset:8192
    ds_read_b64_tr_b16 v[214:215], v56 offset:9216
    v_mfma_f32_16x16x32_bf16 v[36:39], v[196:199], v[132:135], v[36:39]
    ds_read_b64_tr_b16 v[216:217], v57 offset:8192
    v_mfma_f32_16x16x32_bf16 v[40:43], v[200:203], v[132:135], v[40:43]
    ds_read_b64_tr_b16 v[218:219], v57 offset:9216
    v_mfma_f32_16x16x32_bf16 v[44:47], v[196:199], v[136:139], v[44:47]
    v_mfma_f32_16x16x32_bf16 v[48:51], v[200:203], v[136:139], v[48:51]
    s_waitcnt lgkmcnt(0)
    v_mfma_f32_16x16x32_bf16 v[36:39], v[204:207], v[140:143], v[36:39]
    ds_read_b64_tr_b16 v[188:189], v56 offset:16384
    ds_read_b64_tr_b16 v[190:191], v56 offset:17408
    v_mfma_f32_16x16x32_bf16 v[40:43], v[208:211], v[140:143], v[40:43]
    ds_read_b64_tr_b16 v[192:193], v57 offset:16384
    v_mfma_f32_16x16x32_bf16 v[44:47], v[204:207], v[144:147], v[44:47]
    ds_read_b64_tr_b16 v[194:195], v57 offset:17408
    v_mfma_f32_16x16x32_bf16 v[48:51], v[208:211], v[144:147], v[48:51]
    ds_read_b64_tr_b16 v[196:197], v56 offset:24576
    ds_read_b64_tr_b16 v[198:199], v56 offset:25600
    v_mfma_f32_16x16x32_bf16 v[36:39], v[212:215], v[148:151], v[36:39]
    ds_read_b64_tr_b16 v[200:201], v57 offset:24576
    v_mfma_f32_16x16x32_bf16 v[40:43], v[216:219], v[148:151], v[40:43]
    ds_read_b64_tr_b16 v[202:203], v57 offset:25600
    v_mfma_f32_16x16x32_bf16 v[44:47], v[212:215], v[152:155], v[44:47]
    v_mfma_f32_16x16x32_bf16 v[48:51], v[216:219], v[152:155], v[48:51]
    s_waitcnt lgkmcnt(0)
    v_mfma_f32_16x16x32_bf16 v[36:39], v[188:191], v[156:159], v[36:39]
    ds_read_b64_tr_b16 v[204:205], v56 offset:32768
    ds_read_b64_tr_b16 v[206:207], v56 offset:33792
    v_mfma_f32_16x16x32_bf16 v[40:43], v[192:195], v[156:159], v[40:43]
    ds_read_b64_tr_b16 v[208:209], v57 offset:32768
    v_mfma_f32_16x16x32_bf16 v[44:47], v[188:191], v[160:163], v[44:47]
    ds_read_b64_tr_b16 v[210:211], v57 offset:33792
    v_mfma_f32_16x16x32_bf16 v[48:51], v[192:195], v[160:163], v[48:51]
    ds_read_b64_tr_b16 v[212:213], v56 offset:40960
    ds_read_b64_tr_b16 v[214:215], v56 offset:41984
    v_mfma_f32_16x16x32_bf16 v[36:39], v[196:199], v[164:167], v[36:39]
    ds_read_b64_tr_b16 v[216:217], v57 offset:40960
    v_mfma_f32_16x16x32_bf16 v[40:43], v[200:203], v[164:167], v[40:43]
    ds_read_b64_tr_b16 v[218:219], v57 offset:41984
    v_mfma_f32_16x16x32_bf16 v[44:47], v[196:199], v[168:171], v[44:47]
    v_mfma_f32_16x16x32_bf16 v[48:51], v[200:203], v[168:171], v[48:51]
    s_cmp_eq_u32 s3, 0
    s_cbranch_scc0 L_nsf_11
    s_mul_i32 s69, s4, 7168
    s_add_u32 s69, s69, 65536
    v_lshlrev_b32 v14, 4, v0
    v_add_u32 v15, 4096, v14
    buffer_load_dwordx4 v[220:223], v14, s[16:19], s69 offen offset:0 sc1
    buffer_load_dwordx4 v[224:227], v14, s[16:19], s69 offen offset:1024 sc1
    buffer_load_dwordx4 v[228:231], v14, s[16:19], s69 offen offset:2048 sc1
    buffer_load_dwordx4 v[232:235], v14, s[16:19], s69 offen offset:3072 sc1
    buffer_load_dwordx4 v[236:239], v15, s[16:19], s69 offen offset:0 sc1
    buffer_load_dwordx4 v[240:243], v15, s[16:19], s69 offen offset:1024 sc1
    buffer_load_dwordx4 v[244:247], v15, s[16:19], s69 offen offset:2048 sc1
L_nsf_11:
    s_waitcnt lgkmcnt(0)
    v_mfma_f32_16x16x32_bf16 v[36:39], v[204:207], v[172:175], v[36:39]
    v_mfma_f32_16x16x32_bf16 v[40:43], v[208:211], v[172:175], v[40:43]
    v_mfma_f32_16x16x32_bf16 v[44:47], v[204:207], v[176:179], v[44:47]
    v_mfma_f32_16x16x32_bf16 v[48:51], v[208:211], v[176:179], v[48:51]
    v_mfma_f32_16x16x32_bf16 v[36:39], v[212:215], v[180:183], v[36:39]
    v_mfma_f32_16x16x32_bf16 v[40:43], v[216:219], v[180:183], v[40:43]
    v_mfma_f32_16x16x32_bf16 v[44:47], v[212:215], v[184:187], v[44:47]
    v_mfma_f32_16x16x32_bf16 v[48:51], v[216:219], v[184:187], v[48:51]
    s_cmp_eq_u32 s60, 3
    s_cbranch_scc0 L_zx_12
    s_nop 3
    v_mul_f32 v220, v40, v40
    v_mul_f32 v221, v41, v41
    v_mul_f32 v222, v42, v42
    v_mul_f32 v223, v43, v43
    v_mul_f32 v224, v48, v48
    v_mul_f32 v225, v49, v49
    v_mul_f32 v226, v50, v50
    v_mul_f32 v227, v51, v51
    v_fmamk_f32 v220, v220, 0xbdd2d3e8, v12
    v_fmamk_f32 v221, v221, 0xbdd2d3e8, v12
    v_fmamk_f32 v222, v222, 0xbdd2d3e8, v12
    v_fmamk_f32 v223, v223, 0xbdd2d3e8, v12
    v_fmamk_f32 v224, v224, 0xbdd2d3e8, v12
    v_fmamk_f32 v225, v225, 0xbdd2d3e8, v12
    v_fmamk_f32 v226, v226, 0xbdd2d3e8, v12
    v_fmamk_f32 v227, v227, 0xbdd2d3e8, v12
    v_mul_f32 v220, v220, v40
    v_mul_f32 v221, v221, v41
    v_mul_f32 v222, v222, v42
    v_mul_f32 v223, v223, v43
    v_mul_f32 v224, v224, v48
    v_mul_f32 v225, v225, v49
    v_mul_f32 v226, v226, v50
    v_mul_f32 v227, v227, v51
    v_exp_f32 v220, v220
    v_exp_f32 v221, v221
    v_exp_f32 v222, v222
    v_exp_f32 v223, v223
    v_exp_f32 v224, v224
    v_exp_f32 v225, v225
    v_exp_f32 v226, v226
    v_exp_f32 v227, v227
    v_add_f32 v220, 1.0, v220
    v_add_f32 v221, 1.0, v221
    v_add_f32 v222, 1.0, v222
    v_add_f32 v223, 1.0, v223
    v_add_f32 v224, 1.0, v224
    v_add_f32 v225, 1.0, v225
    v_add_f32 v226, 1.0, v226
    v_add_f32 v227, 1.0, v227
    v_rcp_f32 v220, v220
    v_rcp_f32 v221, v221
    v_rcp_f32 v222, v222
    v_rcp_f32 v223, v223
    v_rcp_f32 v224, v224
    v_rcp_f32 v225, v225
    v_rcp_f32 v226, v226
    v_rcp_f32 v227, v227
    v_mul_f32 v40, v40, v220
    v_mul_f32 v41, v41, v221
    v_mul_f32 v42, v42, v222
    v_mul_f32 v43, v43, v223
    v_mul_f32 v48, v48, v224
    v_mul_f32 v49, v49, v225
    v_mul_f32 v50, v50, v226
    v_mul_f32 v51, v51, v227
    v_cvt_pk_bf16_f32 v236, v40, v41
    v_cvt_pk_bf16_f32 v237, v42, v43
    v_cvt_pk_bf16_f32 v238, v48, v49
    v_cvt_pk_bf16_f32 v239, v50, v51
    s_mul_i32 s20, s4, 7
    s_add_u32 s20, s20, s5
    s_lshl_b32 s20, s20, 1
    s_add_u32 s20, s20, s59
    s_lshl_b32 s20, s20, 10
    s_add_u32 s20, s20, 13631488
    v_lshlrev_b32 v19, 4, v0
    buffer_store_dwordx4 v[236:239], v19, s[16:19], s20 offen sc1
L_zx_12:
    v_lshrrev_b32 v4, 4, v0
    v_lshlrev_b32 v4, 6, v4
    s_lshl_b32 s20, s59, 8
    s_add_u32 s20, s20, 163072
    v_add_u32 v4, s20, v4
    s_lshl_b32 s21, s4, 1
    s_add_u32 s21, s21, s59
    s_mul_i32 s21, s21, 7168
    s_add_u32 s21, s21, 1048576
    s_mul_i32 s22, s5, 458752
    s_lshl_b32 s23, s60, 11
    s_add_u32 s22, s22, s23
    s_add_u32 s72, s22, s21
    s_add_u32 s73, s72, 1024
    s_lshl_b32 s23, s5, 10
    s_add_u32 s23, s23, s21
    s_add_u32 s23, s23, 3211264
    s_cmp_eq_u32 s60, 3
    s_cselect_b32 s73, s23, s73
    v_lshlrev_b32 v5, 4, v0
    s_cmp_eq_u32 s3, 0
    s_cbranch_scc0 L_nsc_13
    s_mov_b32 s66, 0
    s_waitcnt vmcnt(0)
    s_branch L_chk_16
L_poll_14:
    buffer_load_dwordx4 v[220:223], v14, s[16:19], s69 offen offset:0 sc1
    buffer_load_dwordx4 v[224:227], v14, s[16:19], s69 offen offset:1024 sc1
    buffer_load_dwordx4 v[228:231], v14, s[16:19], s69 offen offset:2048 sc1
    buffer_load_dwordx4 v[232:235], v14, s[16:19], s69 offen offset:3072 sc1
    buffer_load_dwordx4 v[236:239], v15, s[16:19], s69 offen offset:0 sc1
    buffer_load_dwordx4 v[240:243], v15, s[16:19], s69 offen offset:1024 sc1
    buffer_load_dwordx4 v[244:247], v15, s[16:19], s69 offen offset:2048 sc1
    s_waitcnt vmcnt(0)
L_chk_16:
    v_xor_b32 v16, s6, v221
    v_xor_b32 v17, s7, v223
    v_or_b32 v16, v16, v17
    v_xor_b32 v17, s6, v225
    v_xor_b32 v18, s7, v227
    v_or3_b32 v16, v16, v17, v18
    v_xor_b32 v17, s6, v229
    v_xor_b32 v18, s7, v231
    v_or3_b32 v16, v16, v17, v18
    v_xor_b32 v17, s6, v233
    v_xor_b32 v18, s7, v235
    v_or3_b32 v16, v16, v17, v18
    v_xor_b32 v17, s6, v237
    v_xor_b32 v18, s7, v239
    v_or3_b32 v16, v16, v17, v18
    v_xor_b32 v17, s6, v241
    v_xor_b32 v18, s7, v243
    v_or3_b32 v16, v16, v17, v18
    v_xor_b32 v17, s6, v245
    v_xor_b32 v18, s7, v247
    v_or3_b32 v16, v16, v17, v18
    v_cmp_ne_u32 vcc, 0, v16
    s_add_u32 s66, s66, 1
    s_cmp_eq_u64 vcc, 0
    s_cbranch_scc1 L_polled_15
    s_cmp_lt_u32 s66, 1048576
    s_cbranch_scc0 L_polled_15
    s_branch L_poll_14
L_polled_15:
    v_add_f32 v220, v220, v224
    v_add_f32 v222, v222, v226
    v_add_f32 v220, v220, v228
    v_add_f32 v222, v222, v230
    v_add_f32 v220, v220, v232
    v_add_f32 v222, v222, v234
    v_add_f32 v220, v220, v236
    v_add_f32 v222, v222, v238
    v_add_f32 v220, v220, v240
    v_add_f32 v222, v222, v242
    v_add_f32 v220, v220, v244
    v_add_f32 v222, v222, v246
    v_mul_f32 v220, 0x3a924925, v220
    v_mul_f32 v222, 0x3a924925, v222
    v_fma_f32 v222, -v220, v220, v222
    v_max_f32 v222, 0, v222
    v_add_f32 v222, 0x3727c5ac, v222
    v_rsq_f32 v224, v222
    v_lshlrev_b32 v14, 3, v0
    v_add_u32 v14, 163072, v14
    v_mul_f32 v225, -v220, v224
    ds_write_b64 v14, v[224:225]
    s_waitcnt lgkmcnt(0)
L_nsc_13:
    s_barrier
    ds_read_b128 v[220:223], v4 offset:0
    ds_read_b128 v[224:227], v4 offset:16
    ds_read_b128 v[228:231], v4 offset:32
    ds_read_b128 v[232:235], v4 offset:48
    s_waitcnt lgkmcnt(2)
    v_fma_f32 v20, v20, v220, v221
    v_fma_f32 v21, v21, v222, v223
    v_fma_f32 v22, v22, v224, v225
    v_fma_f32 v23, v23, v226, v227
    v_fma_f32 v24, v24, v220, v221
    v_fma_f32 v25, v25, v222, v223
    v_fma_f32 v26, v26, v224, v225
    v_fma_f32 v27, v27, v226, v227
    v_cvt_pk_bf16_f32 v236, v20, v21
    v_cvt_pk_bf16_f32 v237, v22, v23
    v_cvt_pk_bf16_f32 v240, v24, v25
    v_cvt_pk_bf16_f32 v241, v26, v27
    s_waitcnt lgkmcnt(0)
    v_fma_f32 v28, v28, v228, v229
    v_fma_f32 v29, v29, v230, v231
    v_fma_f32 v30, v30, v232, v233
    v_fma_f32 v31, v31, v234, v235
    v_fma_f32 v32, v32, v228, v229
    v_fma_f32 v33, v33, v230, v231
    v_fma_f32 v34, v34, v232, v233
    v_fma_f32 v35, v35, v234, v235
    v_cvt_pk_bf16_f32 v238, v28, v29
    v_cvt_pk_bf16_f32 v239, v30, v31
    v_cvt_pk_bf16_f32 v242, v32, v33
    v_cvt_pk_bf16_f32 v243, v34, v35
    buffer_store_dwordx4 v[236:239], v5, s[16:19], s72 offen sc1
    buffer_store_dwordx4 v[240:243], v5, s[16:19], s73 offen sc1
L_p1done:
    s_mov_b32 s8, s42
    s_and_b32 s9, s43, 0xffff
    s_mov_b32 s10, 8388608
    s_mov_b32 s11, 0x20000
    v_lshrrev_b32 v6, 4, v0
    v_and_b32 v7, 15, v0
    v_xor_b32 v7, v7, v6
    s_lshl_b32 s20, s60, 4
    v_add_u32 v6, s20, v6
    v_lshlrev_b32 v6, 12, v6
    v_xor_b32 v8, 0, v7
    v_lshl_add_u32 v8, v8, 4, v6
    v_add_u32 v1, 0, v8
    v_xor_b32 v8, 4, v7
    v_lshl_add_u32 v8, v8, 4, v6
    v_add_u32 v2, 16384, v8
    v_xor_b32 v8, 8, v7
    v_lshl_add_u32 v8, v8, 4, v6
    v_add_u32 v3, 32768, v8
    v_xor_b32 v8, 12, v7
    v_lshl_add_u32 v8, v8, 4, v6
    v_add_u32 v4, 49152, v8
    s_lshl_b32 s61, s4, 18
    s_lshl_b32 s62, s60, 12
    s_mul_i32 s69, s4, 0
    s_cmp_eq_u32 s5, 7
    s_cbranch_scc1 L_noz1
    v_mul_f32 v220, v36, v36
    v_mul_f32 v221, v37, v37
    v_mul_f32 v222, v38, v38
    v_mul_f32 v223, v39, v39
    v_mul_f32 v224, v44, v44
    v_mul_f32 v225, v45, v45
    v_mul_f32 v226, v46, v46
    v_mul_f32 v227, v47, v47
    v_fmamk_f32 v220, v220, 0xbdd2d3e8, v12
    v_fmamk_f32 v221, v221, 0xbdd2d3e8, v12
    v_fmamk_f32 v222, v222, 0xbdd2d3e8, v12
    v_fmamk_f32 v223, v223, 0xbdd2d3e8, v12
    v_fmamk_f32 v224, v224, 0xbdd2d3e8, v12
    v_fmamk_f32 v225, v225, 0xbdd2d3e8, v12
    v_fmamk_f32 v226, v226, 0xbdd2d3e8, v12
    v_fmamk_f32 v227, v227, 0xbdd2d3e8, v12
    v_mul_f32 v220, v220, v36
    v_mul_f32 v221, v221, v37
    v_mul_f32 v222, v222, v38
    v_mul_f32 v223, v223, v39
    v_mul_f32 v224, v224, v44
    v_mul_f32 v225, v225, v45
    v_mul_f32 v226, v226, v46
    v_mul_f32 v227, v227, v47
    v_exp_f32 v220, v220
    v_exp_f32 v221, v221
    v_exp_f32 v222, v222
    v_exp_f32 v223, v223
    v_exp_f32 v224, v224
    v_exp_f32 v225, v225
    v_exp_f32 v226, v226
    v_exp_f32 v227, v227
    v_add_f32 v220, 1.0, v220
    v_add_f32 v221, 1.0, v221
    v_add_f32 v222, 1.0, v222
    v_add_f32 v223, 1.0, v223
    v_add_f32 v224, 1.0, v224
    v_add_f32 v225, 1.0, v225
    v_add_f32 v226, 1.0, v226
    v_add_f32 v227, 1.0, v227
    v_rcp_f32 v220, v220
    v_rcp_f32 v221, v221
    v_rcp_f32 v222, v222
    v_rcp_f32 v223, v223
    v_rcp_f32 v224, v224
    v_rcp_f32 v225, v225
    v_rcp_f32 v226, v226
    v_rcp_f32 v227, v227
    v_mul_f32 v36, v36, v220
    v_mul_f32 v37, v37, v221
    v_mul_f32 v38, v38, v222
    v_mul_f32 v39, v39, v223
    v_mul_f32 v44, v44, v224
    v_mul_f32 v45, v45, v225
    v_mul_f32 v46, v46, v226
    v_mul_f32 v47, v47, v227
    v_cvt_pk_bf16_f32 v236, v36, v37
    v_cvt_pk_bf16_f32 v237, v38, v39
    ds_write_b64 v58, v[236:237] offset:0
    v_cvt_pk_bf16_f32 v238, v44, v45
    v_cvt_pk_bf16_f32 v239, v46, v47
    ds_write_b64 v58, v[238:239] offset:32
    s_cmp_eq_u32 s60, 3
    s_cbranch_scc1 L_z1d_400001
    v_mul_f32 v220, v40, v40
    v_mul_f32 v221, v41, v41
    v_mul_f32 v222, v42, v42
    v_mul_f32 v223, v43, v43
    v_mul_f32 v224, v48, v48
    v_mul_f32 v225, v49, v49
    v_mul_f32 v226, v50, v50
    v_mul_f32 v227, v51, v51
    v_fmamk_f32 v220, v220, 0xbdd2d3e8, v12
    v_fmamk_f32 v221, v221, 0xbdd2d3e8, v12
    v_fmamk_f32 v222, v222, 0xbdd2d3e8, v12
    v_fmamk_f32 v223, v223, 0xbdd2d3e8, v12
    v_fmamk_f32 v224, v224, 0xbdd2d3e8, v12
    v_fmamk_f32 v225, v225, 0xbdd2d3e8, v12
    v_fmamk_f32 v226, v226, 0xbdd2d3e8, v12
    v_fmamk_f32 v227, v227, 0xbdd2d3e8, v12
    v_mul_f32 v220, v220, v40
    v_mul_f32 v221, v221, v41
    v_mul_f32 v222, v222, v42
    v_mul_f32 v223, v223, v43
    v_mul_f32 v224, v224, v48
    v_mul_f32 v225, v225, v49
    v_mul_f32 v226, v226, v50
    v_mul_f32 v227, v227, v51
    v_exp_f32 v220, v220
    v_exp_f32 v221, v221
    v_exp_f32 v222, v222
    v_exp_f32 v223, v223
    v_exp_f32 v224, v224
    v_exp_f32 v225, v225
    v_exp_f32 v226, v226
    v_exp_f32 v227, v227
    v_add_f32 v220, 1.0, v220
    v_add_f32 v221, 1.0, v221
    v_add_f32 v222, 1.0, v222
    v_add_f32 v223, 1.0, v223
    v_add_f32 v224, 1.0, v224
    v_add_f32 v225, 1.0, v225
    v_add_f32 v226, 1.0, v226
    v_add_f32 v227, 1.0, v227
    v_rcp_f32 v220, v220
    v_rcp_f32 v221, v221
    v_rcp_f32 v222, v222
    v_rcp_f32 v223, v223
    v_rcp_f32 v224, v224
    v_rcp_f32 v225, v225
    v_rcp_f32 v226, v226
    v_rcp_f32 v227, v227
    v_mul_f32 v40, v40, v220
    v_mul_f32 v41, v41, v221
    v_mul_f32 v42, v42, v222
    v_mul_f32 v43, v43, v223
    v_mul_f32 v48, v48, v224
    v_mul_f32 v49, v49, v225
    v_mul_f32 v50, v50, v226
    v_mul_f32 v51, v51, v227
    v_cvt_pk_bf16_f32 v236, v40, v41
    v_cvt_pk_bf16_f32 v237, v42, v43
    ds_write_b64 v58, v[236:237] offset:512
    v_cvt_pk_bf16_f32 v238, v48, v49
    v_cvt_pk_bf16_f32 v239, v50, v51
    ds_write_b64 v58, v[238:239] offset:544
L_z1d_400001:
L_noz1:
L_z1x:
    s_cmp_lt_u32 s3, 4
    s_cbranch_scc1 L_k2_17
    s_waitcnt vmcnt(0)
    s_branch L_p2
L_k2_17:
    s_waitcnt vmcnt(0)
L_p2:
    s_barrier
    s_cmp_ge_u32 s3, 4
    s_cbranch_scc1 L_ssm
    s_cmp_eq_u32 s5, 7
    s_cbranch_scc1 L_nof1
    s_cmp_eq_u32 s3, 0
    s_cbranch_scc0 L_nf_18
    s_lshl_b32 s20, s5, 5
    s_add_u32 s20, s20, s4
    s_lshl_b32 s20, s20, 7
    s_add_u32 s20, s20, 393216
    v_mov_b32 v14, s6
    v_mov_b32 v15, s7
    v_mov_b32 v16, 0
    s_mov_b64 exec, 1
    buffer_store_dwordx2 v[14:15], v16, s[16:19], s20 offen sc1
    s_mov_b64 exec, -1
L_nf_18:
L_nof1:
    s_add_u32 s22, s69, 0
    s_and_b32 s22, s22, 15
    s_lshl_b32 s23, s22, 8
    s_add_u32 s23, s23, s61
    s_add_u32 m0, s62, 81920
    s_nop 0
    buffer_load_dwordx4 v1, s[8:11], s23 offen lds
    s_add_u32 m0, s62, 82944
    s_nop 0
    buffer_load_dwordx4 v2, s[8:11], s23 offen lds
    s_add_u32 m0, s62, 83968
    s_nop 0
    buffer_load_dwordx4 v3, s[8:11], s23 offen lds
    s_add_u32 m0, s62, 84992
    s_nop 0
    buffer_load_dwordx4 v4, s[8:11], s23 offen lds
    s_add_u32 s22, s69, 1
    s_and_b32 s22, s22, 15
    s_lshl_b32 s23, s22, 8
    s_add_u32 s23, s23, s61
    s_add_u32 m0, s62, 98304
    s_nop 0
    buffer_load_dwordx4 v1, s[8:11], s23 offen lds
    s_add_u32 m0, s62, 99328
    s_nop 0
    buffer_load_dwordx4 v2, s[8:11], s23 offen lds
    s_add_u32 m0, s62, 100352
    s_nop 0
    buffer_load_dwordx4 v3, s[8:11], s23 offen lds
    s_add_u32 m0, s62, 101376
    s_nop 0
    buffer_load_dwordx4 v4, s[8:11], s23 offen lds
    s_add_u32 s22, s69, 2
    s_and_b32 s22, s22, 15
    s_lshl_b32 s23, s22, 8
    s_add_u32 s23, s23, s61
    s_add_u32 m0, s62, 114688
    s_nop 0
    buffer_load_dwordx4 v1, s[8:11], s23 offen lds
    s_add_u32 m0, s62, 115712
    s_nop 0
    buffer_load_dwordx4 v2, s[8:11], s23 offen lds
    s_add_u32 m0, s62, 116736
    s_nop 0
    buffer_load_dwordx4 v3, s[8:11], s23 offen lds
    s_add_u32 m0, s62, 117760
    s_nop 0
    buffer_load_dwordx4 v4, s[8:11], s23 offen lds
    s_add_u32 s22, s69, 3
    s_and_b32 s22, s22, 15
    s_lshl_b32 s23, s22, 8
    s_add_u32 s23, s23, s61
    s_add_u32 m0, s62, 131072
    s_nop 0
    buffer_load_dwordx4 v1, s[8:11], s23 offen lds
    s_add_u32 m0, s62, 132096
    s_nop 0
    buffer_load_dwordx4 v2, s[8:11], s23 offen lds
    s_add_u32 m0, s62, 133120
    s_nop 0
    buffer_load_dwordx4 v3, s[8:11], s23 offen lds
    s_add_u32 m0, s62, 134144
    s_nop 0
    buffer_load_dwordx4 v4, s[8:11], s23 offen lds
    s_add_u32 s22, s69, 4
    s_and_b32 s22, s22, 15
    s_lshl_b32 s23, s22, 8
    s_add_u32 s23, s23, s61
    buffer_load_dwordx4 v[156:159], v1, s[8:11], s23 offen
    buffer_load_dwordx4 v[160:163], v2, s[8:11], s23 offen
    buffer_load_dwordx4 v[164:167], v3, s[8:11], s23 offen
    buffer_load_dwordx4 v[168:171], v4, s[8:11], s23 offen
    s_add_u32 s22, s69, 5
    s_and_b32 s22, s22, 15
    s_lshl_b32 s23, s22, 8
    s_add_u32 s23, s23, s61
    buffer_load_dwordx4 v[172:175], v1, s[8:11], s23 offen
    buffer_load_dwordx4 v[176:179], v2, s[8:11], s23 offen
    buffer_load_dwordx4 v[180:183], v3, s[8:11], s23 offen
    buffer_load_dwordx4 v[184:187], v4, s[8:11], s23 offen
L_wdone:
    v_lshlrev_b32 v220, 4, v0
    v_add_u32 v221, 7168, v220
    v_add_u32 v222, 14336, v220
    v_add_u32 v223, 21504, v220
    v_and_b32 v14, 15, v0
    v_lshrrev_b32 v15, 4, v0
    v_xor_b32 v15, v15, v14
    v_lshlrev_b32 v14, 8, v14
    v_add_u32 v14, 81920, v14
    v_xor_b32 v16, 0, v15
    v_lshl_add_u32 v6, v16, 4, v14
    v_xor_b32 v16, 4, v15
    v_lshl_add_u32 v7, v16, 4, v14
    v_xor_b32 v16, 8, v15
    v_lshl_add_u32 v8, v16, 4, v14
    v_xor_b32 v16, 12, v15
    v_lshl_add_u32 v9, v16, 4, v14
    s_mul_i32 s63, s5, 458752
    s_lshl_b32 s20, s3, 11
    s_add_u32 s63, s63, s20
    s_add_u32 s63, s63, 1048576
    v_lshlrev_b32 v250, 16, v250
    v_lshlrev_b32 v251, 16, v251
    v_lshlrev_b32 v252, 16, v252
    v_lshlrev_b32 v253, 16, v253
    v_lshlrev_b32 v11, 3, v0
    s_lshl_b32 s20, s3, 10
    s_add_u32 s20, s20, 147456
    v_add_u32 v10, s20, v11
    v_and_b32 v11, 31, v0
    v_lshlrev_b32 v11, 4, v11
    v_lshrrev_b32 v16, 5, v0
    v_lshl_add_u32 v11, v16, 3, v11
    s_lshl_b32 s20, s3, 12
    s_add_u32 s20, s20, 81920
    v_add_u32 v246, s20, v220
    s_cmp_eq_u32 s5, 7
    s_cbranch_scc1 L_p7_20
    s_cmp_eq_u32 s3, 0
    s_cbranch_scc0 L_np_19
    v_cmp_gt_u32 vcc, 32, v0
    v_mov_b32 v14, s5
    s_nop 0
    v_cndmask_b32 v14, 7, v14, vcc
    v_lshlrev_b32 v14, 12, v14
    v_and_b32 v15, 31, v0
    v_lshl_add_u32 v14, v15, 7, v14
    s_branch L_pd_21
L_p7_20:
    s_lshl_b32 s21, s3, 6
    v_add_u32 v14, s21, v0
    v_lshlrev_b32 v14, 7, v14
L_pd_21:
    s_mov_b32 s20, 393216
    s_mov_b32 s66, 0
L_poll_22:
    buffer_load_dwordx2 v[16:17], v14, s[16:19], s20 offen sc1
    s_waitcnt vmcnt(0)
L_chk_24:
    v_xor_b32 v240, s6, v16
    v_xor_b32 v241, s7, v17
    v_or_b32 v240, v240, v241
    v_cmp_ne_u32 vcc, 0, v240
    s_add_u32 s66, s66, 1
    s_cmp_eq_u64 vcc, 0
    s_cbranch_scc1 L_polled_23
    s_cmp_lt_u32 s66, 1048576
    s_cbranch_scc0 L_polled_23
    s_mov_b64 exec, vcc
    s_branch L_poll_22
L_polled_23:
    s_mov_b64 exec, -1
    s_cmp_eq_u32 s2, 0
    s_cbranch_scc0 L_np_19
    s_add_u32 s20, s56, 1
    v_mov_b32 v16, s20
    v_mov_b32 v17, 0
    s_mov_b64 exec, 1
    buffer_store_dword v16, v17, s[16:19], 0 offen sc1
    s_mov_b64 exec, -1
L_np_19:
    s_waitcnt vmcnt(20) lgkmcnt(0)
    s_barrier
    s_setprio 1
    s_cmp_eq_u32 s3, 3
    s_cbranch_scc1 L_g2b
    s_add_u32 s21, s69, 0
    s_and_b32 s21, s21, 15
    s_mul_i32 s21, s21, 28672
    s_add_u32 s21, s21, s63
    buffer_load_dwordx4 v[92:95], v220, s[16:19], s21 offen offset:0 sc1
    buffer_load_dwordx4 v[96:99], v220, s[16:19], s21 offen offset:1024 sc1
    buffer_load_dwordx4 v[100:103], v221, s[16:19], s21 offen offset:0 sc1
    buffer_load_dwordx4 v[104:107], v221, s[16:19], s21 offen offset:1024 sc1
    buffer_load_dwordx4 v[108:111], v222, s[16:19], s21 offen offset:0 sc1
    buffer_load_dwordx4 v[112:115], v222, s[16:19], s21 offen offset:1024 sc1
    buffer_load_dwordx4 v[116:119], v223, s[16:19], s21 offen offset:0 sc1
    buffer_load_dwordx4 v[120:123], v223, s[16:19], s21 offen offset:1024 sc1
    s_add_u32 s21, s69, 1
    s_and_b32 s21, s21, 15
    s_mul_i32 s21, s21, 28672
    s_add_u32 s21, s21, s63
    buffer_load_dwordx4 v[124:127], v220, s[16:19], s21 offen offset:0 sc1
    buffer_load_dwordx4 v[128:131], v220, s[16:19], s21 offen offset:1024 sc1
    buffer_load_dwordx4 v[132:135], v221, s[16:19], s21 offen offset:0 sc1
    buffer_load_dwordx4 v[136:139], v221, s[16:19], s21 offen offset:1024 sc1
    ds_read_b128 v[44:47], v6 offset:0
    ds_read_b128 v[48:51], v6 offset:4096
    ds_read_b128 v[52:55], v6 offset:8192
    ds_read_b128 v[56:59], v6 offset:12288
    ds_read_b128 v[60:63], v7 offset:0
    ds_read_b128 v[64:67], v7 offset:4096
    ds_read_b128 v[68:71], v7 offset:8192
    ds_read_b128 v[72:75], v7 offset:12288
    v_and_b32 v5, 15, v0
    s_lshl_b32 s20, s60, 4
    v_add_u32 v5, s20, v5
    v_lshlrev_b32 v5, 2, v5
    s_lshl_b32 s20, s4, 8
    s_add_u32 s20, s20, 16384
    buffer_load_dword v254, v5, s[16:19], s20 offen sc1
    s_waitcnt vmcnt(11) lgkmcnt(4)
    v_mfma_f32_16x16x32_bf16 v[12:15], v[92:95], v[44:47], 0
    ds_read_b128 v[76:79], v8 offset:0
    ds_read_b128 v[80:83], v8 offset:4096
    v_mfma_f32_16x16x32_bf16 v[16:19], v[92:95], v[48:51], 0
    ds_read_b128 v[84:87], v8 offset:8192
    v_mfma_f32_16x16x32_bf16 v[20:23], v[92:95], v[52:55], 0
    ds_read_b128 v[88:91], v8 offset:12288
    buffer_load_dwordx4 v[140:143], v222, s[16:19], s21 offen offset:0 sc1
    v_mfma_f32_16x16x32_bf16 v[24:27], v[92:95], v[56:59], 0
    buffer_load_dwordx4 v[144:147], v222, s[16:19], s21 offen offset:1024 sc1
    v_mfma_f32_16x16x32_bf16 v[28:31], v[96:99], v[44:47], 0
    v_mfma_f32_16x16x32_bf16 v[32:35], v[96:99], v[48:51], 0
    buffer_load_dwordx4 v[148:151], v223, s[16:19], s21 offen offset:0 sc1
    v_mfma_f32_16x16x32_bf16 v[36:39], v[96:99], v[52:55], 0
    v_mfma_f32_16x16x32_bf16 v[40:43], v[96:99], v[56:59], 0
    s_waitcnt vmcnt(12) lgkmcnt(4)
    v_mfma_f32_16x16x32_bf16 v[12:15], v[100:103], v[60:63], v[12:15]
    ds_read_b128 v[44:47], v9 offset:0
    ds_read_b128 v[48:51], v9 offset:4096
    v_mfma_f32_16x16x32_bf16 v[16:19], v[100:103], v[64:67], v[16:19]
    ds_read_b128 v[52:55], v9 offset:8192
    v_mfma_f32_16x16x32_bf16 v[20:23], v[100:103], v[68:71], v[20:23]
    ds_read_b128 v[56:59], v9 offset:12288
    buffer_load_dwordx4 v[152:155], v223, s[16:19], s21 offen offset:1024 sc1
    v_mfma_f32_16x16x32_bf16 v[24:27], v[100:103], v[72:75], v[24:27]
    s_add_u32 s21, s69, 2
    s_and_b32 s21, s21, 15
    s_mul_i32 s21, s21, 28672
    s_add_u32 s21, s21, s63
    buffer_load_dwordx4 v[188:191], v220, s[16:19], s21 offen offset:0 sc1
    v_mfma_f32_16x16x32_bf16 v[28:31], v[104:107], v[60:63], v[28:31]
    v_mfma_f32_16x16x32_bf16 v[32:35], v[104:107], v[64:67], v[32:35]
    buffer_load_dwordx4 v[192:195], v220, s[16:19], s21 offen offset:1024 sc1
    v_mfma_f32_16x16x32_bf16 v[36:39], v[104:107], v[68:71], v[36:39]
    v_mfma_f32_16x16x32_bf16 v[40:43], v[104:107], v[72:75], v[40:43]
    s_waitcnt vmcnt(13) lgkmcnt(0)
    s_barrier
    ds_write_b128 v246, v[156:159] offset:0
    ds_write_b128 v246, v[160:163] offset:1024
    ds_write_b128 v246, v[164:167] offset:2048
    ds_write_b128 v246, v[168:171] offset:3072
    v_mfma_f32_16x16x32_bf16 v[12:15], v[108:111], v[76:79], v[12:15]
    ds_read_b128 v[60:63], v6 offset:16384
    ds_read_b128 v[64:67], v6 offset:20480
    v_mfma_f32_16x16x32_bf16 v[16:19], v[108:111], v[80:83], v[16:19]
    ds_read_b128 v[68:71], v6 offset:24576
    v_mfma_f32_16x16x32_bf16 v[20:23], v[108:111], v[84:87], v[20:23]
    ds_read_b128 v[72:75], v6 offset:28672
    buffer_load_dwordx4 v[196:199], v221, s[16:19], s21 offen offset:0 sc1
    v_mfma_f32_16x16x32_bf16 v[24:27], v[108:111], v[88:91], v[24:27]
    buffer_load_dwordx4 v[200:203], v221, s[16:19], s21 offen offset:1024 sc1
    v_mfma_f32_16x16x32_bf16 v[28:31], v[112:115], v[76:79], v[28:31]
    v_mfma_f32_16x16x32_bf16 v[32:35], v[112:115], v[80:83], v[32:35]
    buffer_load_dwordx4 v[204:207], v222, s[16:19], s21 offen offset:0 sc1
    v_mfma_f32_16x16x32_bf16 v[36:39], v[112:115], v[84:87], v[36:39]
    v_mfma_f32_16x16x32_bf16 v[40:43], v[112:115], v[88:91], v[40:43]
    s_waitcnt vmcnt(14) lgkmcnt(4)
    v_mfma_f32_16x16x32_bf16 v[12:15], v[116:119], v[44:47], v[12:15]
    ds_read_b128 v[76:79], v7 offset:16384
    ds_read_b128 v[80:83], v7 offset:20480
    v_mfma_f32_16x16x32_bf16 v[16:19], v[116:119], v[48:51], v[16:19]
    ds_read_b128 v[84:87], v7 offset:24576
    v_mfma_f32_16x16x32_bf16 v[20:23], v[116:119], v[52:55], v[20:23]
    ds_read_b128 v[88:91], v7 offset:28672
    buffer_load_dwordx4 v[208:211], v222, s[16:19], s21 offen offset:1024 sc1
    v_mfma_f32_16x16x32_bf16 v[24:27], v[116:119], v[56:59], v[24:27]
    buffer_load_dwordx4 v[212:215], v223, s[16:19], s21 offen offset:0 sc1
    v_mfma_f32_16x16x32_bf16 v[28:31], v[120:123], v[44:47], v[28:31]
    v_mfma_f32_16x16x32_bf16 v[32:35], v[120:123], v[48:51], v[32:35]
    buffer_load_dwordx4 v[216:219], v223, s[16:19], s21 offen offset:1024 sc1
    v_mfma_f32_16x16x32_bf16 v[36:39], v[120:123], v[52:55], v[36:39]
    v_mfma_f32_16x16x32_bf16 v[40:43], v[120:123], v[56:59], v[40:43]
    s_waitcnt vmcnt(15) lgkmcnt(4)
    v_mfma_f32_16x16x32_bf16 v[12:15], v[124:127], v[60:63], v[12:15]
    ds_read_b128 v[44:47], v8 offset:16384
    ds_read_b128 v[48:51], v8 offset:20480
    v_mfma_f32_16x16x32_bf16 v[16:19], v[124:127], v[64:67], v[16:19]
    ds_read_b128 v[52:55], v8 offset:24576
    v_mfma_f32_16x16x32_bf16 v[20:23], v[124:127], v[68:71], v[20:23]
    ds_read_b128 v[56:59], v8 offset:28672
    s_add_u32 s21, s69, 3
    s_and_b32 s21, s21, 15
    s_mul_i32 s21, s21, 28672
    s_add_u32 s21, s21, s63
    buffer_load_dwordx4 v[92:95], v220, s[16:19], s21 offen offset:0 sc1
    v_mfma_f32_16x16x32_bf16 v[24:27], v[124:127], v[72:75], v[24:27]
    buffer_load_dwordx4 v[96:99], v220, s[16:19], s21 offen offset:1024 sc1
    v_mfma_f32_16x16x32_bf16 v[28:31], v[128:131], v[60:63], v[28:31]
    v_mfma_f32_16x16x32_bf16 v[32:35], v[128:131], v[64:67], v[32:35]
    buffer_load_dwordx4 v[100:103], v221, s[16:19], s21 offen offset:0 sc1
    v_mfma_f32_16x16x32_bf16 v[36:39], v[128:131], v[68:71], v[36:39]
    v_mfma_f32_16x16x32_bf16 v[40:43], v[128:131], v[72:75], v[40:43]
    s_waitcnt vmcnt(16) lgkmcnt(4)
    v_mfma_f32_16x16x32_bf16 v[12:15], v[132:135], v[76:79], v[12:15]
    ds_read_b128 v[60:63], v9 offset:16384
    ds_read_b128 v[64:67], v9 offset:20480
    v_mfma_f32_16x16x32_bf16 v[16:19], v[132:135], v[80:83], v[16:19]
    ds_read_b128 v[68:71], v9 offset:24576
    v_mfma_f32_16x16x32_bf16 v[20:23], v[132:135], v[84:87], v[20:23]
    ds_read_b128 v[72:75], v9 offset:28672
    buffer_load_dwordx4 v[104:107], v221, s[16:19], s21 offen offset:1024 sc1
    v_mfma_f32_16x16x32_bf16 v[24:27], v[132:135], v[88:91], v[24:27]
    buffer_load_dwordx4 v[108:111], v222, s[16:19], s21 offen offset:0 sc1
    v_mfma_f32_16x16x32_bf16 v[28:31], v[136:139], v[76:79], v[28:31]
    v_mfma_f32_16x16x32_bf16 v[32:35], v[136:139], v[80:83], v[32:35]
    buffer_load_dwordx4 v[112:115], v222, s[16:19], s21 offen offset:1024 sc1
    v_mfma_f32_16x16x32_bf16 v[36:39], v[136:139], v[84:87], v[36:39]
    v_mfma_f32_16x16x32_bf16 v[40:43], v[136:139], v[88:91], v[40:43]
    s_waitcnt vmcnt(16) lgkmcnt(0)
    s_barrier
    ds_write_b128 v246, v[172:175] offset:16384
    ds_write_b128 v246, v[176:179] offset:17408
    ds_write_b128 v246, v[180:183] offset:18432
    ds_write_b128 v246, v[184:187] offset:19456
    v_mfma_f32_16x16x32_bf16 v[12:15], v[140:143], v[44:47], v[12:15]
    ds_read_b128 v[76:79], v6 offset:32768
    ds_read_b128 v[80:83], v6 offset:36864
    v_mfma_f32_16x16x32_bf16 v[16:19], v[140:143], v[48:51], v[16:19]
    ds_read_b128 v[84:87], v6 offset:40960
    v_mfma_f32_16x16x32_bf16 v[20:23], v[140:143], v[52:55], v[20:23]
    ds_read_b128 v[88:91], v6 offset:45056
    buffer_load_dwordx4 v[156:159], v223, s[16:19], s21 offen offset:0 sc1
    v_mfma_f32_16x16x32_bf16 v[24:27], v[140:143], v[56:59], v[24:27]
    buffer_load_dwordx4 v[160:163], v223, s[16:19], s21 offen offset:1024 sc1
    v_mfma_f32_16x16x32_bf16 v[28:31], v[144:147], v[44:47], v[28:31]
    v_mfma_f32_16x16x32_bf16 v[32:35], v[144:147], v[48:51], v[32:35]
    s_add_u32 s21, s69, 4
    s_and_b32 s21, s21, 15
    s_mul_i32 s21, s21, 28672
    s_add_u32 s21, s21, s63
    buffer_load_dwordx4 v[164:167], v220, s[16:19], s21 offen offset:0 sc1
    v_mfma_f32_16x16x32_bf16 v[36:39], v[144:147], v[52:55], v[36:39]
    v_mfma_f32_16x16x32_bf16 v[40:43], v[144:147], v[56:59], v[40:43]
    s_waitcnt vmcnt(17) lgkmcnt(4)
    v_mfma_f32_16x16x32_bf16 v[12:15], v[148:151], v[60:63], v[12:15]
    ds_read_b128 v[44:47], v7 offset:32768
    ds_read_b128 v[48:51], v7 offset:36864
    v_mfma_f32_16x16x32_bf16 v[16:19], v[148:151], v[64:67], v[16:19]
    ds_read_b128 v[52:55], v7 offset:40960
    v_mfma_f32_16x16x32_bf16 v[20:23], v[148:151], v[68:71], v[20:23]
    ds_read_b128 v[56:59], v7 offset:45056
    buffer_load_dwordx4 v[168:171], v220, s[16:19], s21 offen offset:1024 sc1
    v_mfma_f32_16x16x32_bf16 v[24:27], v[148:151], v[72:75], v[24:27]
    buffer_load_dwordx4 v[116:119], v221, s[16:19], s21 offen offset:0 sc1
    v_mfma_f32_16x16x32_bf16 v[28:31], v[152:155], v[60:63], v[28:31]
    v_mfma_f32_16x16x32_bf16 v[32:35], v[152:155], v[64:67], v[32:35]
    buffer_load_dwordx4 v[120:123], v221, s[16:19], s21 offen offset:1024 sc1
    v_mfma_f32_16x16x32_bf16 v[36:39], v[152:155], v[68:71], v[36:39]
    v_mfma_f32_16x16x32_bf16 v[40:43], v[152:155], v[72:75], v[40:43]
    s_waitcnt vmcnt(18) lgkmcnt(4)
    v_mfma_f32_16x16x32_bf16 v[12:15], v[188:191], v[76:79], v[12:15]
    ds_read_b128 v[60:63], v8 offset:32768
    ds_read_b128 v[64:67], v8 offset:36864
    v_mfma_f32_16x16x32_bf16 v[16:19], v[188:191], v[80:83], v[16:19]
    ds_read_b128 v[68:71], v8 offset:40960
    v_mfma_f32_16x16x32_bf16 v[20:23], v[188:191], v[84:87], v[20:23]
    ds_read_b128 v[72:75], v8 offset:45056
    buffer_load_dwordx4 v[124:127], v222, s[16:19], s21 offen offset:0 sc1
    v_mfma_f32_16x16x32_bf16 v[24:27], v[188:191], v[88:91], v[24:27]
    buffer_load_dwordx4 v[128:131], v222, s[16:19], s21 offen offset:1024 sc1
    v_mfma_f32_16x16x32_bf16 v[28:31], v[192:195], v[76:79], v[28:31]
    v_mfma_f32_16x16x32_bf16 v[32:35], v[192:195], v[80:83], v[32:35]
    buffer_load_dwordx4 v[132:135], v223, s[16:19], s21 offen offset:0 sc1
    v_mfma_f32_16x16x32_bf16 v[36:39], v[192:195], v[84:87], v[36:39]
    v_mfma_f32_16x16x32_bf16 v[40:43], v[192:195], v[88:91], v[40:43]
    s_waitcnt vmcnt(19) lgkmcnt(4)
    v_mfma_f32_16x16x32_bf16 v[12:15], v[196:199], v[44:47], v[12:15]
    ds_read_b128 v[76:79], v9 offset:32768
    ds_read_b128 v[80:83], v9 offset:36864
    v_mfma_f32_16x16x32_bf16 v[16:19], v[196:199], v[48:51], v[16:19]
    ds_read_b128 v[84:87], v9 offset:40960
    v_mfma_f32_16x16x32_bf16 v[20:23], v[196:199], v[52:55], v[20:23]
    ds_read_b128 v[88:91], v9 offset:45056
    buffer_load_dwordx4 v[136:139], v223, s[16:19], s21 offen offset:1024 sc1
    v_mfma_f32_16x16x32_bf16 v[24:27], v[196:199], v[56:59], v[24:27]
    s_add_u32 s21, s69, 5
    s_and_b32 s21, s21, 15
    s_mul_i32 s21, s21, 28672
    s_add_u32 s21, s21, s63
    buffer_load_dwordx4 v[140:143], v220, s[16:19], s21 offen offset:0 sc1
    v_mfma_f32_16x16x32_bf16 v[28:31], v[200:203], v[44:47], v[28:31]
    v_mfma_f32_16x16x32_bf16 v[32:35], v[200:203], v[48:51], v[32:35]
    buffer_load_dwordx4 v[144:147], v220, s[16:19], s21 offen offset:1024 sc1
    v_mfma_f32_16x16x32_bf16 v[36:39], v[200:203], v[52:55], v[36:39]
    v_mfma_f32_16x16x32_bf16 v[40:43], v[200:203], v[56:59], v[40:43]
    s_waitcnt vmcnt(20) lgkmcnt(0)
    s_barrier
    v_mfma_f32_16x16x32_bf16 v[12:15], v[204:207], v[60:63], v[12:15]
    ds_read_b128 v[44:47], v6 offset:49152
    ds_read_b128 v[48:51], v6 offset:53248
    v_mfma_f32_16x16x32_bf16 v[16:19], v[204:207], v[64:67], v[16:19]
    ds_read_b128 v[52:55], v6 offset:57344
    v_mfma_f32_16x16x32_bf16 v[20:23], v[204:207], v[68:71], v[20:23]
    ds_read_b128 v[56:59], v6 offset:61440
    s_add_u32 s22, s69, 6
    s_and_b32 s22, s22, 15
    s_lshl_b32 s23, s22, 8
    s_add_u32 s23, s23, s61
    s_add_u32 m0, s62, 114688
    s_nop 0
    buffer_load_dwordx4 v1, s[8:11], s23 offen lds
    v_mfma_f32_16x16x32_bf16 v[24:27], v[204:207], v[72:75], v[24:27]
    s_add_u32 m0, s62, 115712
    s_nop 0
    buffer_load_dwordx4 v2, s[8:11], s23 offen lds
    v_mfma_f32_16x16x32_bf16 v[28:31], v[208:211], v[60:63], v[28:31]
    v_mfma_f32_16x16x32_bf16 v[32:35], v[208:211], v[64:67], v[32:35]
    s_add_u32 m0, s62, 116736
    s_nop 0
    buffer_load_dwordx4 v3, s[8:11], s23 offen lds
    v_mfma_f32_16x16x32_bf16 v[36:39], v[208:211], v[68:71], v[36:39]
    v_mfma_f32_16x16x32_bf16 v[40:43], v[208:211], v[72:75], v[40:43]
    s_waitcnt vmcnt(21) lgkmcnt(4)
    v_mfma_f32_16x16x32_bf16 v[12:15], v[212:215], v[76:79], v[12:15]
    ds_read_b128 v[60:63], v7 offset:49152
    ds_read_b128 v[64:67], v7 offset:53248
    v_mfma_f32_16x16x32_bf16 v[16:19], v[212:215], v[80:83], v[16:19]
    ds_read_b128 v[68:71], v7 offset:57344
    v_mfma_f32_16x16x32_bf16 v[20:23], v[212:215], v[84:87], v[20:23]
    ds_read_b128 v[72:75], v7 offset:61440
    s_add_u32 m0, s62, 117760
    s_nop 0
    buffer_load_dwordx4 v4, s[8:11], s23 offen lds
    v_mfma_f32_16x16x32_bf16 v[24:27], v[212:215], v[88:91], v[24:27]
    buffer_load_dwordx4 v[172:175], v221, s[16:19], s21 offen offset:0 sc1
    v_mfma_f32_16x16x32_bf16 v[28:31], v[216:219], v[76:79], v[28:31]
    v_mfma_f32_16x16x32_bf16 v[32:35], v[216:219], v[80:83], v[32:35]
    buffer_load_dwordx4 v[176:179], v221, s[16:19], s21 offen offset:1024 sc1
    v_mfma_f32_16x16x32_bf16 v[36:39], v[216:219], v[84:87], v[36:39]
    v_mfma_f32_16x16x32_bf16 v[40:43], v[216:219], v[88:91], v[40:43]
    s_waitcnt vmcnt(22) lgkmcnt(4)
    v_mfma_f32_16x16x32_bf16 v[12:15], v[92:95], v[44:47], v[12:15]
    ds_read_b128 v[76:79], v8 offset:49152
    ds_read_b128 v[80:83], v8 offset:53248
    v_mfma_f32_16x16x32_bf16 v[16:19], v[92:95], v[48:51], v[16:19]
    ds_read_b128 v[84:87], v8 offset:57344
    v_mfma_f32_16x16x32_bf16 v[20:23], v[92:95], v[52:55], v[20:23]
    ds_read_b128 v[88:91], v8 offset:61440
    buffer_load_dwordx4 v[180:183], v222, s[16:19], s21 offen offset:0 sc1
    v_mfma_f32_16x16x32_bf16 v[24:27], v[92:95], v[56:59], v[24:27]
    buffer_load_dwordx4 v[184:187], v222, s[16:19], s21 offen offset:1024 sc1
    v_mfma_f32_16x16x32_bf16 v[28:31], v[96:99], v[44:47], v[28:31]
    v_mfma_f32_16x16x32_bf16 v[32:35], v[96:99], v[48:51], v[32:35]
    buffer_load_dwordx4 v[148:151], v223, s[16:19], s21 offen offset:0 sc1
    v_mfma_f32_16x16x32_bf16 v[36:39], v[96:99], v[52:55], v[36:39]
    v_mfma_f32_16x16x32_bf16 v[40:43], v[96:99], v[56:59], v[40:43]
    s_waitcnt vmcnt(23) lgkmcnt(4)
    v_mfma_f32_16x16x32_bf16 v[12:15], v[100:103], v[60:63], v[12:15]
    ds_read_b128 v[44:47], v9 offset:49152
    ds_read_b128 v[48:51], v9 offset:53248
    v_mfma_f32_16x16x32_bf16 v[16:19], v[100:103], v[64:67], v[16:19]
    ds_read_b128 v[52:55], v9 offset:57344
    v_mfma_f32_16x16x32_bf16 v[20:23], v[100:103], v[68:71], v[20:23]
    ds_read_b128 v[56:59], v9 offset:61440
    buffer_load_dwordx4 v[152:155], v223, s[16:19], s21 offen offset:1024 sc1
    v_mfma_f32_16x16x32_bf16 v[24:27], v[100:103], v[72:75], v[24:27]
    s_add_u32 s21, s69, 6
    s_and_b32 s21, s21, 15
    s_mul_i32 s21, s21, 28672
    s_add_u32 s21, s21, s63
    buffer_load_dwordx4 v[188:191], v220, s[16:19], s21 offen offset:0 sc1
    v_mfma_f32_16x16x32_bf16 v[28:31], v[104:107], v[60:63], v[28:31]
    v_mfma_f32_16x16x32_bf16 v[32:35], v[104:107], v[64:67], v[32:35]
    buffer_load_dwordx4 v[192:195], v220, s[16:19], s21 offen offset:1024 sc1
    v_mfma_f32_16x16x32_bf16 v[36:39], v[104:107], v[68:71], v[36:39]
    v_mfma_f32_16x16x32_bf16 v[40:43], v[104:107], v[72:75], v[40:43]
    s_waitcnt vmcnt(24) lgkmcnt(0)
    s_barrier
    v_mfma_f32_16x16x32_bf16 v[12:15], v[108:111], v[76:79], v[12:15]
    ds_read_b128 v[60:63], v6 offset:0
    ds_read_b128 v[64:67], v6 offset:4096
    v_mfma_f32_16x16x32_bf16 v[16:19], v[108:111], v[80:83], v[16:19]
    ds_read_b128 v[68:71], v6 offset:8192
    v_mfma_f32_16x16x32_bf16 v[20:23], v[108:111], v[84:87], v[20:23]
    ds_read_b128 v[72:75], v6 offset:12288
    s_add_u32 s22, s69, 7
    s_and_b32 s22, s22, 15
    s_lshl_b32 s23, s22, 8
    s_add_u32 s23, s23, s61
    s_add_u32 m0, s62, 131072
    s_nop 0
    buffer_load_dwordx4 v1, s[8:11], s23 offen lds
    v_mfma_f32_16x16x32_bf16 v[24:27], v[108:111], v[88:91], v[24:27]
    s_add_u32 m0, s62, 132096
    s_nop 0
    buffer_load_dwordx4 v2, s[8:11], s23 offen lds
    v_mfma_f32_16x16x32_bf16 v[28:31], v[112:115], v[76:79], v[28:31]
    v_mfma_f32_16x16x32_bf16 v[32:35], v[112:115], v[80:83], v[32:35]
    s_add_u32 m0, s62, 133120
    s_nop 0
    buffer_load_dwordx4 v3, s[8:11], s23 offen lds
    v_mfma_f32_16x16x32_bf16 v[36:39], v[112:115], v[84:87], v[36:39]
    v_mfma_f32_16x16x32_bf16 v[40:43], v[112:115], v[88:91], v[40:43]
    s_waitcnt vmcnt(25) lgkmcnt(4)
    v_mfma_f32_16x16x32_bf16 v[12:15], v[156:159], v[44:47], v[12:15]
    ds_read_b128 v[76:79], v7 offset:0
    ds_read_b128 v[80:83], v7 offset:4096
    v_mfma_f32_16x16x32_bf16 v[16:19], v[156:159], v[48:51], v[16:19]
    ds_read_b128 v[84:87], v7 offset:8192
    v_mfma_f32_16x16x32_bf16 v[20:23], v[156:159], v[52:55], v[20:23]
    ds_read_b128 v[88:91], v7 offset:12288
    s_add_u32 m0, s62, 134144
    s_nop 0
    buffer_load_dwordx4 v4, s[8:11], s23 offen lds
    v_mfma_f32_16x16x32_bf16 v[24:27], v[156:159], v[56:59], v[24:27]
    buffer_load_dwordx4 v[196:199], v221, s[16:19], s21 offen offset:0 sc1
    v_mfma_f32_16x16x32_bf16 v[28:31], v[160:163], v[44:47], v[28:31]
    v_mfma_f32_16x16x32_bf16 v[32:35], v[160:163], v[48:51], v[32:35]
    buffer_load_dwordx4 v[200:203], v221, s[16:19], s21 offen offset:1024 sc1
    v_mfma_f32_16x16x32_bf16 v[36:39], v[160:163], v[52:55], v[36:39]
    v_mfma_f32_16x16x32_bf16 v[40:43], v[160:163], v[56:59], v[40:43]
    s_waitcnt vmcnt(26) lgkmcnt(4)
    v_mfma_f32_16x16x32_bf16 v[12:15], v[164:167], v[60:63], v[12:15]
    ds_read_b128 v[44:47], v8 offset:0
    ds_read_b128 v[48:51], v8 offset:4096
    v_mfma_f32_16x16x32_bf16 v[16:19], v[164:167], v[64:67], v[16:19]
    ds_read_b128 v[52:55], v8 offset:8192
    v_mfma_f32_16x16x32_bf16 v[20:23], v[164:167], v[68:71], v[20:23]
    ds_read_b128 v[56:59], v8 offset:12288
    buffer_load_dwordx4 v[204:207], v222, s[16:19], s21 offen offset:0 sc1
    v_mfma_f32_16x16x32_bf16 v[24:27], v[164:167], v[72:75], v[24:27]
    buffer_load_dwordx4 v[208:211], v222, s[16:19], s21 offen offset:1024 sc1
    v_mfma_f32_16x16x32_bf16 v[28:31], v[168:171], v[60:63], v[28:31]
    v_mfma_f32_16x16x32_bf16 v[32:35], v[168:171], v[64:67], v[32:35]
    buffer_load_dwordx4 v[212:215], v223, s[16:19], s21 offen offset:0 sc1
    v_mfma_f32_16x16x32_bf16 v[36:39], v[168:171], v[68:71], v[36:39]
    v_mfma_f32_16x16x32_bf16 v[40:43], v[168:171], v[72:75], v[40:43]
    s_waitcnt vmcnt(27) lgkmcnt(4)
    v_mfma_f32_16x16x32_bf16 v[12:15], v[116:119], v[76:79], v[12:15]
    ds_read_b128 v[60:63], v9 offset:0
    ds_read_b128 v[64:67], v9 offset:4096
    v_mfma_f32_16x16x32_bf16 v[16:19], v[116:119], v[80:83], v[16:19]
    ds_read_b128 v[68:71], v9 offset:8192
    v_mfma_f32_16x16x32_bf16 v[20:23], v[116:119], v[84:87], v[20:23]
    ds_read_b128 v[72:75], v9 offset:12288
    buffer_load_dwordx4 v[216:219], v223, s[16:19], s21 offen offset:1024 sc1
    v_mfma_f32_16x16x32_bf16 v[24:27], v[116:119], v[88:91], v[24:27]
    s_add_u32 s21, s69, 7
    s_and_b32 s21, s21, 15
    s_mul_i32 s21, s21, 28672
    s_add_u32 s21, s21, s63
    buffer_load_dwordx4 v[92:95], v220, s[16:19], s21 offen offset:0 sc1
    v_mfma_f32_16x16x32_bf16 v[28:31], v[120:123], v[76:79], v[28:31]
    v_mfma_f32_16x16x32_bf16 v[32:35], v[120:123], v[80:83], v[32:35]
    buffer_load_dwordx4 v[96:99], v220, s[16:19], s21 offen offset:1024 sc1
    v_mfma_f32_16x16x32_bf16 v[36:39], v[120:123], v[84:87], v[36:39]
    v_mfma_f32_16x16x32_bf16 v[40:43], v[120:123], v[88:91], v[40:43]
    s_waitcnt vmcnt(28) lgkmcnt(0)
    s_barrier
    v_mfma_f32_16x16x32_bf16 v[12:15], v[124:127], v[44:47], v[12:15]
    ds_read_b128 v[76:79], v6 offset:16384
    ds_read_b128 v[80:83], v6 offset:20480
    v_mfma_f32_16x16x32_bf16 v[16:19], v[124:127], v[48:51], v[16:19]
    ds_read_b128 v[84:87], v6 offset:24576
    v_mfma_f32_16x16x32_bf16 v[20:23], v[124:127], v[52:55], v[20:23]
    ds_read_b128 v[88:91], v6 offset:28672
    s_add_u32 s22, s69, 8
    s_and_b32 s22, s22, 15
    s_lshl_b32 s23, s22, 8
    s_add_u32 s23, s23, s61
    s_add_u32 m0, s62, 81920
    s_nop 0
    buffer_load_dwordx4 v1, s[8:11], s23 offen lds
    v_mfma_f32_16x16x32_bf16 v[24:27], v[124:127], v[56:59], v[24:27]
    s_add_u32 m0, s62, 82944
    s_nop 0
    buffer_load_dwordx4 v2, s[8:11], s23 offen lds
    v_mfma_f32_16x16x32_bf16 v[28:31], v[128:131], v[44:47], v[28:31]
    v_mfma_f32_16x16x32_bf16 v[32:35], v[128:131], v[48:51], v[32:35]
    s_add_u32 m0, s62, 83968
    s_nop 0
    buffer_load_dwordx4 v3, s[8:11], s23 offen lds
    v_mfma_f32_16x16x32_bf16 v[36:39], v[128:131], v[52:55], v[36:39]
    v_mfma_f32_16x16x32_bf16 v[40:43], v[128:131], v[56:59], v[40:43]
    s_waitcnt vmcnt(29) lgkmcnt(4)
    v_mfma_f32_16x16x32_bf16 v[12:15], v[132:135], v[60:63], v[12:15]
    ds_read_b128 v[44:47], v7 offset:16384
    ds_read_b128 v[48:51], v7 offset:20480
    v_mfma_f32_16x16x32_bf16 v[16:19], v[132:135], v[64:67], v[16:19]
    ds_read_b128 v[52:55], v7 offset:24576
    v_mfma_f32_16x16x32_bf16 v[20:23], v[132:135], v[68:71], v[20:23]
    ds_read_b128 v[56:59], v7 offset:28672
    s_add_u32 m0, s62, 84992
    s_nop 0
    buffer_load_dwordx4 v4, s[8:11], s23 offen lds
    v_mfma_f32_16x16x32_bf16 v[24:27], v[132:135], v[72:75], v[24:27]
    buffer_load_dwordx4 v[100:103], v221, s[16:19], s21 offen offset:0 sc1
    v_mfma_f32_16x16x32_bf16 v[28:31], v[136:139], v[60:63], v[28:31]
    v_mfma_f32_16x16x32_bf16 v[32:35], v[136:139], v[64:67], v[32:35]
    buffer_load_dwordx4 v[104:107], v221, s[16:19], s21 offen offset:1024 sc1
    v_mfma_f32_16x16x32_bf16 v[36:39], v[136:139], v[68:71], v[36:39]
    v_mfma_f32_16x16x32_bf16 v[40:43], v[136:139], v[72:75], v[40:43]
    s_waitcnt vmcnt(30) lgkmcnt(4)
    v_mfma_f32_16x16x32_bf16 v[12:15], v[140:143], v[76:79], v[12:15]
    ds_read_b128 v[60:63], v8 offset:16384
    ds_read_b128 v[64:67], v8 offset:20480
    v_mfma_f32_16x16x32_bf16 v[16:19], v[140:143], v[80:83], v[16:19]
    ds_read_b128 v[68:71], v8 offset:24576
    v_mfma_f32_16x16x32_bf16 v[20:23], v[140:143], v[84:87], v[20:23]
    ds_read_b128 v[72:75], v8 offset:28672
    buffer_load_dwordx4 v[108:111], v222, s[16:19], s21 offen offset:0 sc1
    v_mfma_f32_16x16x32_bf16 v[24:27], v[140:143], v[88:91], v[24:27]
    buffer_load_dwordx4 v[112:115], v222, s[16:19], s21 offen offset:1024 sc1
    v_mfma_f32_16x16x32_bf16 v[28:31], v[144:147], v[76:79], v[28:31]
    v_mfma_f32_16x16x32_bf16 v[32:35], v[144:147], v[80:83], v[32:35]
    buffer_load_dwordx4 v[156:159], v223, s[16:19], s21 offen offset:0 sc1
    v_mfma_f32_16x16x32_bf16 v[36:39], v[144:147], v[84:87], v[36:39]
    v_mfma_f32_16x16x32_bf16 v[40:43], v[144:147], v[88:91], v[40:43]
    s_waitcnt vmcnt(27) lgkmcnt(4)
    v_mfma_f32_16x16x32_bf16 v[12:15], v[172:175], v[44:47], v[12:15]
    ds_read_b128 v[76:79], v9 offset:16384
    ds_read_b128 v[80:83], v9 offset:20480
    v_mfma_f32_16x16x32_bf16 v[16:19], v[172:175], v[48:51], v[16:19]
    ds_read_b128 v[84:87], v9 offset:24576
    v_mfma_f32_16x16x32_bf16 v[20:23], v[172:175], v[52:55], v[20:23]
    ds_read_b128 v[88:91], v9 offset:28672
    buffer_load_dwordx4 v[160:163], v223, s[16:19], s21 offen offset:1024 sc1
    v_mfma_f32_16x16x32_bf16 v[24:27], v[172:175], v[56:59], v[24:27]
    s_add_u32 s21, s69, 8
    s_and_b32 s21, s21, 15
    s_mul_i32 s21, s21, 28672
    s_add_u32 s21, s21, s63
    buffer_load_dwordx4 v[164:167], v220, s[16:19], s21 offen offset:0 sc1
    v_mfma_f32_16x16x32_bf16 v[28:31], v[176:179], v[44:47], v[28:31]
    v_mfma_f32_16x16x32_bf16 v[32:35], v[176:179], v[48:51], v[32:35]
    buffer_load_dwordx4 v[168:171], v220, s[16:19], s21 offen offset:1024 sc1
    v_mfma_f32_16x16x32_bf16 v[36:39], v[176:179], v[52:55], v[36:39]
    v_mfma_f32_16x16x32_bf16 v[40:43], v[176:179], v[56:59], v[40:43]
    s_waitcnt vmcnt(28) lgkmcnt(0)
    s_barrier
    v_mfma_f32_16x16x32_bf16 v[12:15], v[180:183], v[60:63], v[12:15]
    ds_read_b128 v[44:47], v6 offset:32768
    ds_read_b128 v[48:51], v6 offset:36864
    v_mfma_f32_16x16x32_bf16 v[16:19], v[180:183], v[64:67], v[16:19]
    ds_read_b128 v[52:55], v6 offset:40960
    v_mfma_f32_16x16x32_bf16 v[20:23], v[180:183], v[68:71], v[20:23]
    ds_read_b128 v[56:59], v6 offset:45056
    s_add_u32 s22, s69, 9
    s_and_b32 s22, s22, 15
    s_lshl_b32 s23, s22, 8
    s_add_u32 s23, s23, s61
    s_add_u32 m0, s62, 98304
    s_nop 0
    buffer_load_dwordx4 v1, s[8:11], s23 offen lds
    v_mfma_f32_16x16x32_bf16 v[24:27], v[180:183], v[72:75], v[24:27]
    s_add_u32 m0, s62, 99328
    s_nop 0
    buffer_load_dwordx4 v2, s[8:11], s23 offen lds
    v_mfma_f32_16x16x32_bf16 v[28:31], v[184:187], v[60:63], v[28:31]
    v_mfma_f32_16x16x32_bf16 v[32:35], v[184:187], v[64:67], v[32:35]
    s_add_u32 m0, s62, 100352
    s_nop 0
    buffer_load_dwordx4 v3, s[8:11], s23 offen lds
    v_mfma_f32_16x16x32_bf16 v[36:39], v[184:187], v[68:71], v[36:39]
    v_mfma_f32_16x16x32_bf16 v[40:43], v[184:187], v[72:75], v[40:43]
    s_waitcnt vmcnt(29) lgkmcnt(4)
    v_mfma_f32_16x16x32_bf16 v[12:15], v[148:151], v[76:79], v[12:15]
    ds_read_b128 v[60:63], v7 offset:32768
    ds_read_b128 v[64:67], v7 offset:36864
    v_mfma_f32_16x16x32_bf16 v[16:19], v[148:151], v[80:83], v[16:19]
    ds_read_b128 v[68:71], v7 offset:40960
    v_mfma_f32_16x16x32_bf16 v[20:23], v[148:151], v[84:87], v[20:23]
    ds_read_b128 v[72:75], v7 offset:45056
    s_add_u32 m0, s62, 101376
    s_nop 0
    buffer_load_dwordx4 v4, s[8:11], s23 offen lds
    v_mfma_f32_16x16x32_bf16 v[24:27], v[148:151], v[88:91], v[24:27]
    buffer_load_dwordx4 v[116:119], v221, s[16:19], s21 offen offset:0 sc1
    v_mfma_f32_16x16x32_bf16 v[28:31], v[152:155], v[76:79], v[28:31]
    v_mfma_f32_16x16x32_bf16 v[32:35], v[152:155], v[80:83], v[32:35]
    buffer_load_dwordx4 v[120:123], v221, s[16:19], s21 offen offset:1024 sc1
    v_mfma_f32_16x16x32_bf16 v[36:39], v[152:155], v[84:87], v[36:39]
    v_mfma_f32_16x16x32_bf16 v[40:43], v[152:155], v[88:91], v[40:43]
    s_waitcnt vmcnt(30) lgkmcnt(4)
    v_mfma_f32_16x16x32_bf16 v[12:15], v[188:191], v[44:47], v[12:15]
    ds_read_b128 v[76:79], v8 offset:32768
    ds_read_b128 v[80:83], v8 offset:36864
    v_mfma_f32_16x16x32_bf16 v[16:19], v[188:191], v[48:51], v[16:19]
    ds_read_b128 v[84:87], v8 offset:40960
    v_mfma_f32_16x16x32_bf16 v[20:23], v[188:191], v[52:55], v[20:23]
    ds_read_b128 v[88:91], v8 offset:45056
    buffer_load_dwordx4 v[124:127], v222, s[16:19], s21 offen offset:0 sc1
    v_mfma_f32_16x16x32_bf16 v[24:27], v[188:191], v[56:59], v[24:27]
    buffer_load_dwordx4 v[128:131], v222, s[16:19], s21 offen offset:1024 sc1
    v_mfma_f32_16x16x32_bf16 v[28:31], v[192:195], v[44:47], v[28:31]
    v_mfma_f32_16x16x32_bf16 v[32:35], v[192:195], v[48:51], v[32:35]
    buffer_load_dwordx4 v[132:135], v223, s[16:19], s21 offen offset:0 sc1
    v_mfma_f32_16x16x32_bf16 v[36:39], v[192:195], v[52:55], v[36:39]
    v_mfma_f32_16x16x32_bf16 v[40:43], v[192:195], v[56:59], v[40:43]
    s_waitcnt vmcnt(27) lgkmcnt(4)
    v_mfma_f32_16x16x32_bf16 v[12:15], v[196:199], v[60:63], v[12:15]
    ds_read_b128 v[44:47], v9 offset:32768
    ds_read_b128 v[48:51], v9 offset:36864
    v_mfma_f32_16x16x32_bf16 v[16:19], v[196:199], v[64:67], v[16:19]
    ds_read_b128 v[52:55], v9 offset:40960
    v_mfma_f32_16x16x32_bf16 v[20:23], v[196:199], v[68:71], v[20:23]
    ds_read_b128 v[56:59], v9 offset:45056
    buffer_load_dwordx4 v[136:139], v223, s[16:19], s21 offen offset:1024 sc1
    v_mfma_f32_16x16x32_bf16 v[24:27], v[196:199], v[72:75], v[24:27]
    s_add_u32 s21, s69, 9
    s_and_b32 s21, s21, 15
    s_mul_i32 s21, s21, 28672
    s_add_u32 s21, s21, s63
    buffer_load_dwordx4 v[140:143], v220, s[16:19], s21 offen offset:0 sc1
    v_mfma_f32_16x16x32_bf16 v[28:31], v[200:203], v[60:63], v[28:31]
    v_mfma_f32_16x16x32_bf16 v[32:35], v[200:203], v[64:67], v[32:35]
    buffer_load_dwordx4 v[144:147], v220, s[16:19], s21 offen offset:1024 sc1
    v_mfma_f32_16x16x32_bf16 v[36:39], v[200:203], v[68:71], v[36:39]
    v_mfma_f32_16x16x32_bf16 v[40:43], v[200:203], v[72:75], v[40:43]
    s_waitcnt vmcnt(28) lgkmcnt(0)
    s_barrier
    v_mfma_f32_16x16x32_bf16 v[12:15], v[204:207], v[76:79], v[12:15]
    ds_read_b128 v[60:63], v6 offset:49152
    ds_read_b128 v[64:67], v6 offset:53248
    v_mfma_f32_16x16x32_bf16 v[16:19], v[204:207], v[80:83], v[16:19]
    ds_read_b128 v[68:71], v6 offset:57344
    v_mfma_f32_16x16x32_bf16 v[20:23], v[204:207], v[84:87], v[20:23]
    ds_read_b128 v[72:75], v6 offset:61440
    s_add_u32 s22, s69, 10
    s_and_b32 s22, s22, 15
    s_lshl_b32 s23, s22, 8
    s_add_u32 s23, s23, s61
    s_add_u32 m0, s62, 114688
    s_nop 0
    buffer_load_dwordx4 v1, s[8:11], s23 offen lds
    v_mfma_f32_16x16x32_bf16 v[24:27], v[204:207], v[88:91], v[24:27]
    s_add_u32 m0, s62, 115712
    s_nop 0
    buffer_load_dwordx4 v2, s[8:11], s23 offen lds
    v_mfma_f32_16x16x32_bf16 v[28:31], v[208:211], v[76:79], v[28:31]
    v_mfma_f32_16x16x32_bf16 v[32:35], v[208:211], v[80:83], v[32:35]
    s_add_u32 m0, s62, 116736
    s_nop 0
    buffer_load_dwordx4 v3, s[8:11], s23 offen lds
    v_mfma_f32_16x16x32_bf16 v[36:39], v[208:211], v[84:87], v[36:39]
    v_mfma_f32_16x16x32_bf16 v[40:43], v[208:211], v[88:91], v[40:43]
    s_waitcnt vmcnt(29) lgkmcnt(4)
    v_mfma_f32_16x16x32_bf16 v[12:15], v[212:215], v[44:47], v[12:15]
    ds_read_b128 v[76:79], v7 offset:49152
    ds_read_b128 v[80:83], v7 offset:53248
    v_mfma_f32_16x16x32_bf16 v[16:19], v[212:215], v[48:51], v[16:19]
    ds_read_b128 v[84:87], v7 offset:57344
    v_mfma_f32_16x16x32_bf16 v[20:23], v[212:215], v[52:55], v[20:23]
    ds_read_b128 v[88:91], v7 offset:61440
    s_add_u32 m0, s62, 117760
    s_nop 0
    buffer_load_dwordx4 v4, s[8:11], s23 offen lds
    v_mfma_f32_16x16x32_bf16 v[24:27], v[212:215], v[56:59], v[24:27]
    buffer_load_dwordx4 v[172:175], v221, s[16:19], s21 offen offset:0 sc1
    v_mfma_f32_16x16x32_bf16 v[28:31], v[216:219], v[44:47], v[28:31]
    v_mfma_f32_16x16x32_bf16 v[32:35], v[216:219], v[48:51], v[32:35]
    buffer_load_dwordx4 v[176:179], v221, s[16:19], s21 offen offset:1024 sc1
    v_mfma_f32_16x16x32_bf16 v[36:39], v[216:219], v[52:55], v[36:39]
    v_mfma_f32_16x16x32_bf16 v[40:43], v[216:219], v[56:59], v[40:43]
    s_waitcnt vmcnt(30) lgkmcnt(4)
    v_mfma_f32_16x16x32_bf16 v[12:15], v[92:95], v[60:63], v[12:15]
    ds_read_b128 v[44:47], v8 offset:49152
    ds_read_b128 v[48:51], v8 offset:53248
    v_mfma_f32_16x16x32_bf16 v[16:19], v[92:95], v[64:67], v[16:19]
    ds_read_b128 v[52:55], v8 offset:57344
    v_mfma_f32_16x16x32_bf16 v[20:23], v[92:95], v[68:71], v[20:23]
    ds_read_b128 v[56:59], v8 offset:61440
    buffer_load_dwordx4 v[180:183], v222, s[16:19], s21 offen offset:0 sc1
    v_mfma_f32_16x16x32_bf16 v[24:27], v[92:95], v[72:75], v[24:27]
    buffer_load_dwordx4 v[184:187], v222, s[16:19], s21 offen offset:1024 sc1
    v_mfma_f32_16x16x32_bf16 v[28:31], v[96:99], v[60:63], v[28:31]
    v_mfma_f32_16x16x32_bf16 v[32:35], v[96:99], v[64:67], v[32:35]
    buffer_load_dwordx4 v[148:151], v223, s[16:19], s21 offen offset:0 sc1
    v_mfma_f32_16x16x32_bf16 v[36:39], v[96:99], v[68:71], v[36:39]
    v_mfma_f32_16x16x32_bf16 v[40:43], v[96:99], v[72:75], v[40:43]
    s_waitcnt vmcnt(27) lgkmcnt(4)
    v_mfma_f32_16x16x32_bf16 v[12:15], v[100:103], v[76:79], v[12:15]
    ds_read_b128 v[60:63], v9 offset:49152
    ds_read_b128 v[64:67], v9 offset:53248
    v_mfma_f32_16x16x32_bf16 v[16:19], v[100:103], v[80:83], v[16:19]
    ds_read_b128 v[68:71], v9 offset:57344
    v_mfma_f32_16x16x32_bf16 v[20:23], v[100:103], v[84:87], v[20:23]
    ds_read_b128 v[72:75], v9 offset:61440
    buffer_load_dwordx4 v[152:155], v223, s[16:19], s21 offen offset:1024 sc1
    v_mfma_f32_16x16x32_bf16 v[24:27], v[100:103], v[88:91], v[24:27]
    s_add_u32 s21, s69, 10
    s_and_b32 s21, s21, 15
    s_mul_i32 s21, s21, 28672
    s_add_u32 s21, s21, s63
    buffer_load_dwordx4 v[188:191], v220, s[16:19], s21 offen offset:0 sc1
    v_mfma_f32_16x16x32_bf16 v[28:31], v[104:107], v[76:79], v[28:31]
    v_mfma_f32_16x16x32_bf16 v[32:35], v[104:107], v[80:83], v[32:35]
    buffer_load_dwordx4 v[192:195], v220, s[16:19], s21 offen offset:1024 sc1
    v_mfma_f32_16x16x32_bf16 v[36:39], v[104:107], v[84:87], v[36:39]
    v_mfma_f32_16x16x32_bf16 v[40:43], v[104:107], v[88:91], v[40:43]
    s_waitcnt vmcnt(28) lgkmcnt(0)
    s_barrier
    v_mfma_f32_16x16x32_bf16 v[12:15], v[108:111], v[44:47], v[12:15]
    ds_read_b128 v[76:79], v6 offset:0
    ds_read_b128 v[80:83], v6 offset:4096
    v_mfma_f32_16x16x32_bf16 v[16:19], v[108:111], v[48:51], v[16:19]
    ds_read_b128 v[84:87], v6 offset:8192
    v_mfma_f32_16x16x32_bf16 v[20:23], v[108:111], v[52:55], v[20:23]
    ds_read_b128 v[88:91], v6 offset:12288
    s_add_u32 s22, s69, 11
    s_and_b32 s22, s22, 15
    s_lshl_b32 s23, s22, 8
    s_add_u32 s23, s23, s61
    s_add_u32 m0, s62, 131072
    s_nop 0
    buffer_load_dwordx4 v1, s[8:11], s23 offen lds
    v_mfma_f32_16x16x32_bf16 v[24:27], v[108:111], v[56:59], v[24:27]
    s_add_u32 m0, s62, 132096
    s_nop 0
    buffer_load_dwordx4 v2, s[8:11], s23 offen lds
    v_mfma_f32_16x16x32_bf16 v[28:31], v[112:115], v[44:47], v[28:31]
    v_mfma_f32_16x16x32_bf16 v[32:35], v[112:115], v[48:51], v[32:35]
    s_add_u32 m0, s62, 133120
    s_nop 0
    buffer_load_dwordx4 v3, s[8:11], s23 offen lds
    v_mfma_f32_16x16x32_bf16 v[36:39], v[112:115], v[52:55], v[36:39]
    v_mfma_f32_16x16x32_bf16 v[40:43], v[112:115], v[56:59], v[40:43]
    s_waitcnt vmcnt(29) lgkmcnt(4)
    v_mfma_f32_16x16x32_bf16 v[12:15], v[156:159], v[60:63], v[12:15]
    ds_read_b128 v[44:47], v7 offset:0
    ds_read_b128 v[48:51], v7 offset:4096
    v_mfma_f32_16x16x32_bf16 v[16:19], v[156:159], v[64:67], v[16:19]
    ds_read_b128 v[52:55], v7 offset:8192
    v_mfma_f32_16x16x32_bf16 v[20:23], v[156:159], v[68:71], v[20:23]
    ds_read_b128 v[56:59], v7 offset:12288
    s_add_u32 m0, s62, 134144
    s_nop 0
    buffer_load_dwordx4 v4, s[8:11], s23 offen lds
    v_mfma_f32_16x16x32_bf16 v[24:27], v[156:159], v[72:75], v[24:27]
    buffer_load_dwordx4 v[196:199], v221, s[16:19], s21 offen offset:0 sc1
    v_mfma_f32_16x16x32_bf16 v[28:31], v[160:163], v[60:63], v[28:31]
    v_mfma_f32_16x16x32_bf16 v[32:35], v[160:163], v[64:67], v[32:35]
    buffer_load_dwordx4 v[200:203], v221, s[16:19], s21 offen offset:1024 sc1
    v_mfma_f32_16x16x32_bf16 v[36:39], v[160:163], v[68:71], v[36:39]
    v_mfma_f32_16x16x32_bf16 v[40:43], v[160:163], v[72:75], v[40:43]
    s_waitcnt vmcnt(30) lgkmcnt(4)
    v_mfma_f32_16x16x32_bf16 v[12:15], v[164:167], v[76:79], v[12:15]
    ds_read_b128 v[60:63], v8 offset:0
    ds_read_b128 v[64:67], v8 offset:4096
    v_mfma_f32_16x16x32_bf16 v[16:19], v[164:167], v[80:83], v[16:19]
    ds_read_b128 v[68:71], v8 offset:8192
    v_mfma_f32_16x16x32_bf16 v[20:23], v[164:167], v[84:87], v[20:23]
    ds_read_b128 v[72:75], v8 offset:12288
    buffer_load_dwordx4 v[204:207], v222, s[16:19], s21 offen offset:0 sc1
    v_mfma_f32_16x16x32_bf16 v[24:27], v[164:167], v[88:91], v[24:27]
    buffer_load_dwordx4 v[208:211], v222, s[16:19], s21 offen offset:1024 sc1
    v_mfma_f32_16x16x32_bf16 v[28:31], v[168:171], v[76:79], v[28:31]
    v_mfma_f32_16x16x32_bf16 v[32:35], v[168:171], v[80:83], v[32:35]
    buffer_load_dwordx4 v[212:215], v223, s[16:19], s21 offen offset:0 sc1
    v_mfma_f32_16x16x32_bf16 v[36:39], v[168:171], v[84:87], v[36:39]
    v_mfma_f32_16x16x32_bf16 v[40:43], v[168:171], v[88:91], v[40:43]
    s_waitcnt vmcnt(27) lgkmcnt(4)
    v_mfma_f32_16x16x32_bf16 v[12:15], v[116:119], v[44:47], v[12:15]
    ds_read_b128 v[76:79], v9 offset:0
    ds_read_b128 v[80:83], v9 offset:4096
    v_mfma_f32_16x16x32_bf16 v[16:19], v[116:119], v[48:51], v[16:19]
    ds_read_b128 v[84:87], v9 offset:8192
    v_mfma_f32_16x16x32_bf16 v[20:23], v[116:119], v[52:55], v[20:23]
    ds_read_b128 v[88:91], v9 offset:12288
    buffer_load_dwordx4 v[216:219], v223, s[16:19], s21 offen offset:1024 sc1
    v_mfma_f32_16x16x32_bf16 v[24:27], v[116:119], v[56:59], v[24:27]
    s_add_u32 s21, s69, 11
    s_and_b32 s21, s21, 15
    s_mul_i32 s21, s21, 28672
    s_add_u32 s21, s21, s63
    buffer_load_dwordx4 v[92:95], v220, s[16:19], s21 offen offset:0 sc1
    v_mfma_f32_16x16x32_bf16 v[28:31], v[120:123], v[44:47], v[28:31]
    v_mfma_f32_16x16x32_bf16 v[32:35], v[120:123], v[48:51], v[32:35]
    buffer_load_dwordx4 v[96:99], v220, s[16:19], s21 offen offset:1024 sc1
    v_mfma_f32_16x16x32_bf16 v[36:39], v[120:123], v[52:55], v[36:39]
    v_mfma_f32_16x16x32_bf16 v[40:43], v[120:123], v[56:59], v[40:43]
    s_waitcnt vmcnt(28) lgkmcnt(0)
    s_barrier
    v_mfma_f32_16x16x32_bf16 v[12:15], v[124:127], v[60:63], v[12:15]
    ds_read_b128 v[44:47], v6 offset:16384
    ds_read_b128 v[48:51], v6 offset:20480
    v_mfma_f32_16x16x32_bf16 v[16:19], v[124:127], v[64:67], v[16:19]
    ds_read_b128 v[52:55], v6 offset:24576
    v_mfma_f32_16x16x32_bf16 v[20:23], v[124:127], v[68:71], v[20:23]
    ds_read_b128 v[56:59], v6 offset:28672
    s_add_u32 s22, s69, 12
    s_and_b32 s22, s22, 15
    s_lshl_b32 s23, s22, 8
    s_add_u32 s23, s23, s61
    s_add_u32 m0, s62, 81920
    s_nop 0
    buffer_load_dwordx4 v1, s[8:11], s23 offen lds
    v_mfma_f32_16x16x32_bf16 v[24:27], v[124:127], v[72:75], v[24:27]
    s_add_u32 m0, s62, 82944
    s_nop 0
    buffer_load_dwordx4 v2, s[8:11], s23 offen lds
    v_mfma_f32_16x16x32_bf16 v[28:31], v[128:131], v[60:63], v[28:31]
    v_mfma_f32_16x16x32_bf16 v[32:35], v[128:131], v[64:67], v[32:35]
    s_add_u32 m0, s62, 83968
    s_nop 0
    buffer_load_dwordx4 v3, s[8:11], s23 offen lds
    v_mfma_f32_16x16x32_bf16 v[36:39], v[128:131], v[68:71], v[36:39]
    v_mfma_f32_16x16x32_bf16 v[40:43], v[128:131], v[72:75], v[40:43]
    s_waitcnt vmcnt(29) lgkmcnt(4)
    v_mfma_f32_16x16x32_bf16 v[12:15], v[132:135], v[76:79], v[12:15]
    ds_read_b128 v[60:63], v7 offset:16384
    ds_read_b128 v[64:67], v7 offset:20480
    v_mfma_f32_16x16x32_bf16 v[16:19], v[132:135], v[80:83], v[16:19]
    ds_read_b128 v[68:71], v7 offset:24576
    v_mfma_f32_16x16x32_bf16 v[20:23], v[132:135], v[84:87], v[20:23]
    ds_read_b128 v[72:75], v7 offset:28672
    s_add_u32 m0, s62, 84992
    s_nop 0
    buffer_load_dwordx4 v4, s[8:11], s23 offen lds
    v_mfma_f32_16x16x32_bf16 v[24:27], v[132:135], v[88:91], v[24:27]
    buffer_load_dwordx4 v[100:103], v221, s[16:19], s21 offen offset:0 sc1
    v_mfma_f32_16x16x32_bf16 v[28:31], v[136:139], v[76:79], v[28:31]
    v_mfma_f32_16x16x32_bf16 v[32:35], v[136:139], v[80:83], v[32:35]
    buffer_load_dwordx4 v[104:107], v221, s[16:19], s21 offen offset:1024 sc1
    v_mfma_f32_16x16x32_bf16 v[36:39], v[136:139], v[84:87], v[36:39]
    v_mfma_f32_16x16x32_bf16 v[40:43], v[136:139], v[88:91], v[40:43]
    s_waitcnt vmcnt(30) lgkmcnt(4)
    v_mfma_f32_16x16x32_bf16 v[12:15], v[140:143], v[44:47], v[12:15]
    ds_read_b128 v[76:79], v8 offset:16384
    ds_read_b128 v[80:83], v8 offset:20480
    v_mfma_f32_16x16x32_bf16 v[16:19], v[140:143], v[48:51], v[16:19]
    ds_read_b128 v[84:87], v8 offset:24576
    v_mfma_f32_16x16x32_bf16 v[20:23], v[140:143], v[52:55], v[20:23]
    ds_read_b128 v[88:91], v8 offset:28672
    buffer_load_dwordx4 v[108:111], v222, s[16:19], s21 offen offset:0 sc1
    v_mfma_f32_16x16x32_bf16 v[24:27], v[140:143], v[56:59], v[24:27]
    buffer_load_dwordx4 v[112:115], v222, s[16:19], s21 offen offset:1024 sc1
    v_mfma_f32_16x16x32_bf16 v[28:31], v[144:147], v[44:47], v[28:31]
    v_mfma_f32_16x16x32_bf16 v[32:35], v[144:147], v[48:51], v[32:35]
    buffer_load_dwordx4 v[156:159], v223, s[16:19], s21 offen offset:0 sc1
    v_mfma_f32_16x16x32_bf16 v[36:39], v[144:147], v[52:55], v[36:39]
    v_mfma_f32_16x16x32_bf16 v[40:43], v[144:147], v[56:59], v[40:43]
    s_waitcnt vmcnt(27) lgkmcnt(4)
    v_mfma_f32_16x16x32_bf16 v[12:15], v[172:175], v[60:63], v[12:15]
    ds_read_b128 v[44:47], v9 offset:16384
    ds_read_b128 v[48:51], v9 offset:20480
    v_mfma_f32_16x16x32_bf16 v[16:19], v[172:175], v[64:67], v[16:19]
    ds_read_b128 v[52:55], v9 offset:24576
    v_mfma_f32_16x16x32_bf16 v[20:23], v[172:175], v[68:71], v[20:23]
    ds_read_b128 v[56:59], v9 offset:28672
    buffer_load_dwordx4 v[160:163], v223, s[16:19], s21 offen offset:1024 sc1
    v_mfma_f32_16x16x32_bf16 v[24:27], v[172:175], v[72:75], v[24:27]
    s_add_u32 s21, s69, 12
    s_and_b32 s21, s21, 15
    s_mul_i32 s21, s21, 28672
    s_add_u32 s21, s21, s63
    buffer_load_dwordx4 v[164:167], v220, s[16:19], s21 offen offset:0 sc1
    v_mfma_f32_16x16x32_bf16 v[28:31], v[176:179], v[60:63], v[28:31]
    v_mfma_f32_16x16x32_bf16 v[32:35], v[176:179], v[64:67], v[32:35]
    buffer_load_dwordx4 v[168:171], v220, s[16:19], s21 offen offset:1024 sc1
    v_mfma_f32_16x16x32_bf16 v[36:39], v[176:179], v[68:71], v[36:39]
    v_mfma_f32_16x16x32_bf16 v[40:43], v[176:179], v[72:75], v[40:43]
    s_waitcnt vmcnt(28) lgkmcnt(0)
    s_barrier
    v_mfma_f32_16x16x32_bf16 v[12:15], v[180:183], v[76:79], v[12:15]
    ds_read_b128 v[60:63], v6 offset:32768
    ds_read_b128 v[64:67], v6 offset:36864
    v_mfma_f32_16x16x32_bf16 v[16:19], v[180:183], v[80:83], v[16:19]
    ds_read_b128 v[68:71], v6 offset:40960
    v_mfma_f32_16x16x32_bf16 v[20:23], v[180:183], v[84:87], v[20:23]
    ds_read_b128 v[72:75], v6 offset:45056
    s_add_u32 s22, s69, 13
    s_and_b32 s22, s22, 15
    s_lshl_b32 s23, s22, 8
    s_add_u32 s23, s23, s61
    s_add_u32 m0, s62, 98304
    s_nop 0
    buffer_load_dwordx4 v1, s[8:11], s23 offen lds
    v_mfma_f32_16x16x32_bf16 v[24:27], v[180:183], v[88:91], v[24:27]
    s_add_u32 m0, s62, 99328
    s_nop 0
    buffer_load_dwordx4 v2, s[8:11], s23 offen lds
    v_mfma_f32_16x16x32_bf16 v[28:31], v[184:187], v[76:79], v[28:31]
    v_mfma_f32_16x16x32_bf16 v[32:35], v[184:187], v[80:83], v[32:35]
    s_add_u32 m0, s62, 100352
    s_nop 0
    buffer_load_dwordx4 v3, s[8:11], s23 offen lds
    v_mfma_f32_16x16x32_bf16 v[36:39], v[184:187], v[84:87], v[36:39]
    v_mfma_f32_16x16x32_bf16 v[40:43], v[184:187], v[88:91], v[40:43]
    s_waitcnt vmcnt(29) lgkmcnt(4)
    v_mfma_f32_16x16x32_bf16 v[12:15], v[148:151], v[44:47], v[12:15]
    ds_read_b128 v[76:79], v7 offset:32768
    ds_read_b128 v[80:83], v7 offset:36864
    v_mfma_f32_16x16x32_bf16 v[16:19], v[148:151], v[48:51], v[16:19]
    ds_read_b128 v[84:87], v7 offset:40960
    v_mfma_f32_16x16x32_bf16 v[20:23], v[148:151], v[52:55], v[20:23]
    ds_read_b128 v[88:91], v7 offset:45056
    s_add_u32 m0, s62, 101376
    s_nop 0
    buffer_load_dwordx4 v4, s[8:11], s23 offen lds
    v_mfma_f32_16x16x32_bf16 v[24:27], v[148:151], v[56:59], v[24:27]
    buffer_load_dwordx4 v[116:119], v221, s[16:19], s21 offen offset:0 sc1
    v_mfma_f32_16x16x32_bf16 v[28:31], v[152:155], v[44:47], v[28:31]
    v_mfma_f32_16x16x32_bf16 v[32:35], v[152:155], v[48:51], v[32:35]
    buffer_load_dwordx4 v[120:123], v221, s[16:19], s21 offen offset:1024 sc1
    v_mfma_f32_16x16x32_bf16 v[36:39], v[152:155], v[52:55], v[36:39]
    v_mfma_f32_16x16x32_bf16 v[40:43], v[152:155], v[56:59], v[40:43]
    s_waitcnt vmcnt(30) lgkmcnt(4)
    v_mfma_f32_16x16x32_bf16 v[12:15], v[188:191], v[60:63], v[12:15]
    ds_read_b128 v[44:47], v8 offset:32768
    ds_read_b128 v[48:51], v8 offset:36864
    v_mfma_f32_16x16x32_bf16 v[16:19], v[188:191], v[64:67], v[16:19]
    ds_read_b128 v[52:55], v8 offset:40960
    v_mfma_f32_16x16x32_bf16 v[20:23], v[188:191], v[68:71], v[20:23]
    ds_read_b128 v[56:59], v8 offset:45056
    buffer_load_dwordx4 v[124:127], v222, s[16:19], s21 offen offset:0 sc1
    v_mfma_f32_16x16x32_bf16 v[24:27], v[188:191], v[72:75], v[24:27]
    buffer_load_dwordx4 v[128:131], v222, s[16:19], s21 offen offset:1024 sc1
    v_mfma_f32_16x16x32_bf16 v[28:31], v[192:195], v[60:63], v[28:31]
    v_mfma_f32_16x16x32_bf16 v[32:35], v[192:195], v[64:67], v[32:35]
    buffer_load_dwordx4 v[132:135], v223, s[16:19], s21 offen offset:0 sc1
    v_mfma_f32_16x16x32_bf16 v[36:39], v[192:195], v[68:71], v[36:39]
    v_mfma_f32_16x16x32_bf16 v[40:43], v[192:195], v[72:75], v[40:43]
    s_waitcnt vmcnt(27) lgkmcnt(4)
    v_mfma_f32_16x16x32_bf16 v[12:15], v[196:199], v[76:79], v[12:15]
    ds_read_b128 v[60:63], v9 offset:32768
    ds_read_b128 v[64:67], v9 offset:36864
    v_mfma_f32_16x16x32_bf16 v[16:19], v[196:199], v[80:83], v[16:19]
    ds_read_b128 v[68:71], v9 offset:40960
    v_mfma_f32_16x16x32_bf16 v[20:23], v[196:199], v[84:87], v[20:23]
    ds_read_b128 v[72:75], v9 offset:45056
    buffer_load_dwordx4 v[136:139], v223, s[16:19], s21 offen offset:1024 sc1
    v_mfma_f32_16x16x32_bf16 v[24:27], v[196:199], v[88:91], v[24:27]
    s_add_u32 s21, s69, 13
    s_and_b32 s21, s21, 15
    s_mul_i32 s21, s21, 28672
    s_add_u32 s21, s21, s63
    buffer_load_dwordx4 v[140:143], v220, s[16:19], s21 offen offset:0 sc1
    v_mfma_f32_16x16x32_bf16 v[28:31], v[200:203], v[76:79], v[28:31]
    v_mfma_f32_16x16x32_bf16 v[32:35], v[200:203], v[80:83], v[32:35]
    buffer_load_dwordx4 v[144:147], v220, s[16:19], s21 offen offset:1024 sc1
    v_mfma_f32_16x16x32_bf16 v[36:39], v[200:203], v[84:87], v[36:39]
    v_mfma_f32_16x16x32_bf16 v[40:43], v[200:203], v[88:91], v[40:43]
    s_waitcnt vmcnt(28) lgkmcnt(0)
    s_barrier
    v_mfma_f32_16x16x32_bf16 v[12:15], v[204:207], v[44:47], v[12:15]
    ds_read_b128 v[76:79], v6 offset:49152
    ds_read_b128 v[80:83], v6 offset:53248
    v_mfma_f32_16x16x32_bf16 v[16:19], v[204:207], v[48:51], v[16:19]
    ds_read_b128 v[84:87], v6 offset:57344
    v_mfma_f32_16x16x32_bf16 v[20:23], v[204:207], v[52:55], v[20:23]
    ds_read_b128 v[88:91], v6 offset:61440
    s_add_u32 s22, s69, 14
    s_and_b32 s22, s22, 15
    s_lshl_b32 s23, s22, 8
    s_add_u32 s23, s23, s61
    s_add_u32 m0, s62, 114688
    s_nop 0
    buffer_load_dwordx4 v1, s[8:11], s23 offen lds
    v_mfma_f32_16x16x32_bf16 v[24:27], v[204:207], v[56:59], v[24:27]
    s_add_u32 m0, s62, 115712
    s_nop 0
    buffer_load_dwordx4 v2, s[8:11], s23 offen lds
    v_mfma_f32_16x16x32_bf16 v[28:31], v[208:211], v[44:47], v[28:31]
    v_mfma_f32_16x16x32_bf16 v[32:35], v[208:211], v[48:51], v[32:35]
    s_add_u32 m0, s62, 116736
    s_nop 0
    buffer_load_dwordx4 v3, s[8:11], s23 offen lds
    v_mfma_f32_16x16x32_bf16 v[36:39], v[208:211], v[52:55], v[36:39]
    v_mfma_f32_16x16x32_bf16 v[40:43], v[208:211], v[56:59], v[40:43]
    s_waitcnt vmcnt(29) lgkmcnt(4)
    v_mfma_f32_16x16x32_bf16 v[12:15], v[212:215], v[60:63], v[12:15]
    ds_read_b128 v[44:47], v7 offset:49152
    ds_read_b128 v[48:51], v7 offset:53248
    v_mfma_f32_16x16x32_bf16 v[16:19], v[212:215], v[64:67], v[16:19]
    ds_read_b128 v[52:55], v7 offset:57344
    v_mfma_f32_16x16x32_bf16 v[20:23], v[212:215], v[68:71], v[20:23]
    ds_read_b128 v[56:59], v7 offset:61440
    s_add_u32 m0, s62, 117760
    s_nop 0
    buffer_load_dwordx4 v4, s[8:11], s23 offen lds
    v_mfma_f32_16x16x32_bf16 v[24:27], v[212:215], v[72:75], v[24:27]
    buffer_load_dwordx4 v[172:175], v221, s[16:19], s21 offen offset:0 sc1
    v_mfma_f32_16x16x32_bf16 v[28:31], v[216:219], v[60:63], v[28:31]
    v_mfma_f32_16x16x32_bf16 v[32:35], v[216:219], v[64:67], v[32:35]
    buffer_load_dwordx4 v[176:179], v221, s[16:19], s21 offen offset:1024 sc1
    v_mfma_f32_16x16x32_bf16 v[36:39], v[216:219], v[68:71], v[36:39]
    v_mfma_f32_16x16x32_bf16 v[40:43], v[216:219], v[72:75], v[40:43]
    s_waitcnt vmcnt(30) lgkmcnt(4)
    v_mfma_f32_16x16x32_bf16 v[12:15], v[92:95], v[76:79], v[12:15]
    ds_read_b128 v[60:63], v8 offset:49152
    ds_read_b128 v[64:67], v8 offset:53248
    v_mfma_f32_16x16x32_bf16 v[16:19], v[92:95], v[80:83], v[16:19]
    ds_read_b128 v[68:71], v8 offset:57344
    v_mfma_f32_16x16x32_bf16 v[20:23], v[92:95], v[84:87], v[20:23]
    ds_read_b128 v[72:75], v8 offset:61440
    buffer_load_dwordx4 v[180:183], v222, s[16:19], s21 offen offset:0 sc1
    v_mfma_f32_16x16x32_bf16 v[24:27], v[92:95], v[88:91], v[24:27]
    buffer_load_dwordx4 v[184:187], v222, s[16:19], s21 offen offset:1024 sc1
    v_mfma_f32_16x16x32_bf16 v[28:31], v[96:99], v[76:79], v[28:31]
    v_mfma_f32_16x16x32_bf16 v[32:35], v[96:99], v[80:83], v[32:35]
    buffer_load_dwordx4 v[148:151], v223, s[16:19], s21 offen offset:0 sc1
    v_mfma_f32_16x16x32_bf16 v[36:39], v[96:99], v[84:87], v[36:39]
    v_mfma_f32_16x16x32_bf16 v[40:43], v[96:99], v[88:91], v[40:43]
    s_waitcnt vmcnt(27) lgkmcnt(4)
    v_mfma_f32_16x16x32_bf16 v[12:15], v[100:103], v[44:47], v[12:15]
    ds_read_b128 v[76:79], v9 offset:49152
    ds_read_b128 v[80:83], v9 offset:53248
    v_mfma_f32_16x16x32_bf16 v[16:19], v[100:103], v[48:51], v[16:19]
    ds_read_b128 v[84:87], v9 offset:57344
    v_mfma_f32_16x16x32_bf16 v[20:23], v[100:103], v[52:55], v[20:23]
    ds_read_b128 v[88:91], v9 offset:61440
    buffer_load_dwordx4 v[152:155], v223, s[16:19], s21 offen offset:1024 sc1
    v_mfma_f32_16x16x32_bf16 v[24:27], v[100:103], v[56:59], v[24:27]
    s_add_u32 s21, s69, 14
    s_and_b32 s21, s21, 15
    s_mul_i32 s21, s21, 28672
    s_add_u32 s21, s21, s63
    buffer_load_dwordx4 v[188:191], v220, s[16:19], s21 offen offset:0 sc1
    v_mfma_f32_16x16x32_bf16 v[28:31], v[104:107], v[44:47], v[28:31]
    v_mfma_f32_16x16x32_bf16 v[32:35], v[104:107], v[48:51], v[32:35]
    buffer_load_dwordx4 v[192:195], v220, s[16:19], s21 offen offset:1024 sc1
    v_mfma_f32_16x16x32_bf16 v[36:39], v[104:107], v[52:55], v[36:39]
    v_mfma_f32_16x16x32_bf16 v[40:43], v[104:107], v[56:59], v[40:43]
    s_waitcnt vmcnt(28) lgkmcnt(0)
    s_barrier
    v_mfma_f32_16x16x32_bf16 v[12:15], v[108:111], v[60:63], v[12:15]
    ds_read_b128 v[44:47], v6 offset:0
    ds_read_b128 v[48:51], v6 offset:4096
    v_mfma_f32_16x16x32_bf16 v[16:19], v[108:111], v[64:67], v[16:19]
    ds_read_b128 v[52:55], v6 offset:8192
    v_mfma_f32_16x16x32_bf16 v[20:23], v[108:111], v[68:71], v[20:23]
    ds_read_b128 v[56:59], v6 offset:12288
    s_add_u32 s22, s69, 15
    s_and_b32 s22, s22, 15
    s_lshl_b32 s23, s22, 8
    s_add_u32 s23, s23, s61
    s_add_u32 m0, s62, 131072
    s_nop 0
    buffer_load_dwordx4 v1, s[8:11], s23 offen lds
    v_mfma_f32_16x16x32_bf16 v[24:27], v[108:111], v[72:75], v[24:27]
    s_add_u32 m0, s62, 132096
    s_nop 0
    buffer_load_dwordx4 v2, s[8:11], s23 offen lds
    v_mfma_f32_16x16x32_bf16 v[28:31], v[112:115], v[60:63], v[28:31]
    v_mfma_f32_16x16x32_bf16 v[32:35], v[112:115], v[64:67], v[32:35]
    s_add_u32 m0, s62, 133120
    s_nop 0
    buffer_load_dwordx4 v3, s[8:11], s23 offen lds
    v_mfma_f32_16x16x32_bf16 v[36:39], v[112:115], v[68:71], v[36:39]
    v_mfma_f32_16x16x32_bf16 v[40:43], v[112:115], v[72:75], v[40:43]
    s_waitcnt vmcnt(29) lgkmcnt(4)
    v_mfma_f32_16x16x32_bf16 v[12:15], v[156:159], v[76:79], v[12:15]
    ds_read_b128 v[60:63], v7 offset:0
    ds_read_b128 v[64:67], v7 offset:4096
    v_mfma_f32_16x16x32_bf16 v[16:19], v[156:159], v[80:83], v[16:19]
    ds_read_b128 v[68:71], v7 offset:8192
    v_mfma_f32_16x16x32_bf16 v[20:23], v[156:159], v[84:87], v[20:23]
    ds_read_b128 v[72:75], v7 offset:12288
    s_add_u32 m0, s62, 134144
    s_nop 0
    buffer_load_dwordx4 v4, s[8:11], s23 offen lds
    v_mfma_f32_16x16x32_bf16 v[24:27], v[156:159], v[88:91], v[24:27]
    buffer_load_dwordx4 v[196:199], v221, s[16:19], s21 offen offset:0 sc1
    v_mfma_f32_16x16x32_bf16 v[28:31], v[160:163], v[76:79], v[28:31]
    v_mfma_f32_16x16x32_bf16 v[32:35], v[160:163], v[80:83], v[32:35]
    buffer_load_dwordx4 v[200:203], v221, s[16:19], s21 offen offset:1024 sc1
    v_mfma_f32_16x16x32_bf16 v[36:39], v[160:163], v[84:87], v[36:39]
    v_mfma_f32_16x16x32_bf16 v[40:43], v[160:163], v[88:91], v[40:43]
    s_waitcnt vmcnt(30) lgkmcnt(4)
    v_mfma_f32_16x16x32_bf16 v[12:15], v[164:167], v[44:47], v[12:15]
    ds_read_b128 v[76:79], v8 offset:0
    ds_read_b128 v[80:83], v8 offset:4096
    v_mfma_f32_16x16x32_bf16 v[16:19], v[164:167], v[48:51], v[16:19]
    ds_read_b128 v[84:87], v8 offset:8192
    v_mfma_f32_16x16x32_bf16 v[20:23], v[164:167], v[52:55], v[20:23]
    ds_read_b128 v[88:91], v8 offset:12288
    buffer_load_dwordx4 v[204:207], v222, s[16:19], s21 offen offset:0 sc1
    v_mfma_f32_16x16x32_bf16 v[24:27], v[164:167], v[56:59], v[24:27]
    buffer_load_dwordx4 v[208:211], v222, s[16:19], s21 offen offset:1024 sc1
    v_mfma_f32_16x16x32_bf16 v[28:31], v[168:171], v[44:47], v[28:31]
    v_mfma_f32_16x16x32_bf16 v[32:35], v[168:171], v[48:51], v[32:35]
    buffer_load_dwordx4 v[212:215], v223, s[16:19], s21 offen offset:0 sc1
    v_mfma_f32_16x16x32_bf16 v[36:39], v[168:171], v[52:55], v[36:39]
    v_mfma_f32_16x16x32_bf16 v[40:43], v[168:171], v[56:59], v[40:43]
    s_waitcnt vmcnt(27) lgkmcnt(4)
    v_mfma_f32_16x16x32_bf16 v[12:15], v[116:119], v[60:63], v[12:15]
    ds_read_b128 v[44:47], v9 offset:0
    ds_read_b128 v[48:51], v9 offset:4096
    v_mfma_f32_16x16x32_bf16 v[16:19], v[116:119], v[64:67], v[16:19]
    ds_read_b128 v[52:55], v9 offset:8192
    v_mfma_f32_16x16x32_bf16 v[20:23], v[116:119], v[68:71], v[20:23]
    ds_read_b128 v[56:59], v9 offset:12288
    buffer_load_dwordx4 v[216:219], v223, s[16:19], s21 offen offset:1024 sc1
    v_mfma_f32_16x16x32_bf16 v[24:27], v[116:119], v[72:75], v[24:27]
    s_add_u32 s21, s69, 15
    s_and_b32 s21, s21, 15
    s_mul_i32 s21, s21, 28672
    s_add_u32 s21, s21, s63
    buffer_load_dwordx4 v[92:95], v220, s[16:19], s21 offen offset:0 sc1
    v_mfma_f32_16x16x32_bf16 v[28:31], v[120:123], v[60:63], v[28:31]
    v_mfma_f32_16x16x32_bf16 v[32:35], v[120:123], v[64:67], v[32:35]
    buffer_load_dwordx4 v[96:99], v220, s[16:19], s21 offen offset:1024 sc1
    v_mfma_f32_16x16x32_bf16 v[36:39], v[120:123], v[68:71], v[36:39]
    v_mfma_f32_16x16x32_bf16 v[40:43], v[120:123], v[72:75], v[40:43]
    s_waitcnt vmcnt(28) lgkmcnt(0)
    s_barrier
    v_mfma_f32_16x16x32_bf16 v[12:15], v[124:127], v[76:79], v[12:15]
    ds_read_b128 v[60:63], v6 offset:16384
    ds_read_b128 v[64:67], v6 offset:20480
    v_mfma_f32_16x16x32_bf16 v[16:19], v[124:127], v[80:83], v[16:19]
    ds_read_b128 v[68:71], v6 offset:24576
    v_mfma_f32_16x16x32_bf16 v[20:23], v[124:127], v[84:87], v[20:23]
    ds_read_b128 v[72:75], v6 offset:28672
    buffer_load_dwordx4 v[100:103], v221, s[16:19], s21 offen offset:0 sc1
    v_mfma_f32_16x16x32_bf16 v[24:27], v[124:127], v[88:91], v[24:27]
    buffer_load_dwordx4 v[104:107], v221, s[16:19], s21 offen offset:1024 sc1
    v_mfma_f32_16x16x32_bf16 v[28:31], v[128:131], v[76:79], v[28:31]
    v_mfma_f32_16x16x32_bf16 v[32:35], v[128:131], v[80:83], v[32:35]
    buffer_load_dwordx4 v[108:111], v222, s[16:19], s21 offen offset:0 sc1
    v_mfma_f32_16x16x32_bf16 v[36:39], v[128:131], v[84:87], v[36:39]
    v_mfma_f32_16x16x32_bf16 v[40:43], v[128:131], v[88:91], v[40:43]
    s_waitcnt vmcnt(29) lgkmcnt(4)
    v_mfma_f32_16x16x32_bf16 v[12:15], v[132:135], v[44:47], v[12:15]
    ds_read_b128 v[76:79], v7 offset:16384
    ds_read_b128 v[80:83], v7 offset:20480
    v_mfma_f32_16x16x32_bf16 v[16:19], v[132:135], v[48:51], v[16:19]
    ds_read_b128 v[84:87], v7 offset:24576
    v_mfma_f32_16x16x32_bf16 v[20:23], v[132:135], v[52:55], v[20:23]
    ds_read_b128 v[88:91], v7 offset:28672
    buffer_load_dwordx4 v[112:115], v222, s[16:19], s21 offen offset:1024 sc1
    v_mfma_f32_16x16x32_bf16 v[24:27], v[132:135], v[56:59], v[24:27]
    buffer_load_dwordx4 v[156:159], v223, s[16:19], s21 offen offset:0 sc1
    v_mfma_f32_16x16x32_bf16 v[28:31], v[136:139], v[44:47], v[28:31]
    v_mfma_f32_16x16x32_bf16 v[32:35], v[136:139], v[48:51], v[32:35]
    buffer_load_dwordx4 v[160:163], v223, s[16:19], s21 offen offset:1024 sc1
    v_mfma_f32_16x16x32_bf16 v[36:39], v[136:139], v[52:55], v[36:39]
    v_mfma_f32_16x16x32_bf16 v[40:43], v[136:139], v[56:59], v[40:43]
    s_waitcnt vmcnt(30) lgkmcnt(4)
    v_mfma_f32_16x16x32_bf16 v[12:15], v[140:143], v[60:63], v[12:15]
    ds_read_b128 v[44:47], v8 offset:16384
    ds_read_b128 v[48:51], v8 offset:20480
    v_mfma_f32_16x16x32_bf16 v[16:19], v[140:143], v[64:67], v[16:19]
    ds_read_b128 v[52:55], v8 offset:24576
    v_mfma_f32_16x16x32_bf16 v[20:23], v[140:143], v[68:71], v[20:23]
    ds_read_b128 v[56:59], v8 offset:28672
    v_mfma_f32_16x16x32_bf16 v[24:27], v[140:143], v[72:75], v[24:27]
    v_mfma_f32_16x16x32_bf16 v[28:31], v[144:147], v[60:63], v[28:31]
    v_mfma_f32_16x16x32_bf16 v[32:35], v[144:147], v[64:67], v[32:35]
    v_mfma_f32_16x16x32_bf16 v[36:39], v[144:147], v[68:71], v[36:39]
    v_mfma_f32_16x16x32_bf16 v[40:43], v[144:147], v[72:75], v[40:43]
    s_waitcnt vmcnt(24) lgkmcnt(4)
    v_mfma_f32_16x16x32_bf16 v[12:15], v[172:175], v[76:79], v[12:15]
    ds_read_b128 v[60:63], v9 offset:16384
    ds_read_b128 v[64:67], v9 offset:20480
    v_mfma_f32_16x16x32_bf16 v[16:19], v[172:175], v[80:83], v[16:19]
    ds_read_b128 v[68:71], v9 offset:24576
    v_mfma_f32_16x16x32_bf16 v[20:23], v[172:175], v[84:87], v[20:23]
    ds_read_b128 v[72:75], v9 offset:28672
    v_mfma_f32_16x16x32_bf16 v[24:27], v[172:175], v[88:91], v[24:27]
    v_mfma_f32_16x16x32_bf16 v[28:31], v[176:179], v[76:79], v[28:31]
    v_mfma_f32_16x16x32_bf16 v[32:35], v[176:179], v[80:83], v[32:35]
    v_mfma_f32_16x16x32_bf16 v[36:39], v[176:179], v[84:87], v[36:39]
    v_mfma_f32_16x16x32_bf16 v[40:43], v[176:179], v[88:91], v[40:43]
    s_waitcnt vmcnt(22) lgkmcnt(0)
    s_barrier
    v_mfma_f32_16x16x32_bf16 v[12:15], v[180:183], v[44:47], v[12:15]
    ds_read_b128 v[76:79], v6 offset:32768
    ds_read_b128 v[80:83], v6 offset:36864
    v_mfma_f32_16x16x32_bf16 v[16:19], v[180:183], v[48:51], v[16:19]
    ds_read_b128 v[84:87], v6 offset:40960
    v_mfma_f32_16x16x32_bf16 v[20:23], v[180:183], v[52:55], v[20:23]
    ds_read_b128 v[88:91], v6 offset:45056
    v_mfma_f32_16x16x32_bf16 v[24:27], v[180:183], v[56:59], v[24:27]
    v_mfma_f32_16x16x32_bf16 v[28:31], v[184:187], v[44:47], v[28:31]
    v_mfma_f32_16x16x32_bf16 v[32:35], v[184:187], v[48:51], v[32:35]
    v_mfma_f32_16x16x32_bf16 v[36:39], v[184:187], v[52:55], v[36:39]
    v_mfma_f32_16x16x32_bf16 v[40:43], v[184:187], v[56:59], v[40:43]
    s_waitcnt vmcnt(20) lgkmcnt(4)
    v_mfma_f32_16x16x32_bf16 v[12:15], v[148:151], v[60:63], v[12:15]
    ds_read_b128 v[44:47], v7 offset:32768
    ds_read_b128 v[48:51], v7 offset:36864
    v_mfma_f32_16x16x32_bf16 v[16:19], v[148:151], v[64:67], v[16:19]
    ds_read_b128 v[52:55], v7 offset:40960
    v_mfma_f32_16x16x32_bf16 v[20:23], v[148:151], v[68:71], v[20:23]
    ds_read_b128 v[56:59], v7 offset:45056
    v_mfma_f32_16x16x32_bf16 v[24:27], v[148:151], v[72:75], v[24:27]
    v_mfma_f32_16x16x32_bf16 v[28:31], v[152:155], v[60:63], v[28:31]
    v_mfma_f32_16x16x32_bf16 v[32:35], v[152:155], v[64:67], v[32:35]
    v_mfma_f32_16x16x32_bf16 v[36:39], v[152:155], v[68:71], v[36:39]
    v_mfma_f32_16x16x32_bf16 v[40:43], v[152:155], v[72:75], v[40:43]
    s_waitcnt vmcnt(18) lgkmcnt(4)
    v_mfma_f32_16x16x32_bf16 v[12:15], v[188:191], v[76:79], v[12:15]
    ds_read_b128 v[60:63], v8 offset:32768
    ds_read_b128 v[64:67], v8 offset:36864
    v_mfma_f32_16x16x32_bf16 v[16:19], v[188:191], v[80:83], v[16:19]
    ds_read_b128 v[68:71], v8 offset:40960
    v_mfma_f32_16x16x32_bf16 v[20:23], v[188:191], v[84:87], v[20:23]
    ds_read_b128 v[72:75], v8 offset:45056
    v_mfma_f32_16x16x32_bf16 v[24:27], v[188:191], v[88:91], v[24:27]
    v_mfma_f32_16x16x32_bf16 v[28:31], v[192:195], v[76:79], v[28:31]
    v_mfma_f32_16x16x32_bf16 v[32:35], v[192:195], v[80:83], v[32:35]
    v_mfma_f32_16x16x32_bf16 v[36:39], v[192:195], v[84:87], v[36:39]
    v_mfma_f32_16x16x32_bf16 v[40:43], v[192:195], v[88:91], v[40:43]
    s_waitcnt vmcnt(12) lgkmcnt(4)
    v_mfma_f32_16x16x32_bf16 v[12:15], v[196:199], v[44:47], v[12:15]
    ds_read_b128 v[76:79], v9 offset:32768
    ds_read_b128 v[80:83], v9 offset:36864
    ds_read_b64 v[224:225], v10 offset:0
    v_mfma_f32_16x16x32_bf16 v[16:19], v[196:199], v[48:51], v[16:19]
    ds_read_b128 v[84:87], v9 offset:40960
    ds_read_b64 v[226:227], v10 offset:512
    v_mfma_f32_16x16x32_bf16 v[20:23], v[196:199], v[52:55], v[20:23]
    ds_read_b128 v[88:91], v9 offset:45056
    ds_read_b64 v[228:229], v10 offset:3584
    v_mfma_f32_16x16x32_bf16 v[24:27], v[196:199], v[56:59], v[24:27]
    ds_read_b64 v[230:231], v10 offset:4096
    v_mfma_f32_16x16x32_bf16 v[28:31], v[200:203], v[44:47], v[28:31]
    ds_read_b64 v[232:233], v10 offset:7168
    v_mfma_f32_16x16x32_bf16 v[32:35], v[200:203], v[48:51], v[32:35]
    ds_read_b64 v[234:235], v10 offset:7680
    v_mfma_f32_16x16x32_bf16 v[36:39], v[200:203], v[52:55], v[36:39]
    ds_read_b64 v[236:237], v10 offset:10752
    v_mfma_f32_16x16x32_bf16 v[40:43], v[200:203], v[56:59], v[40:43]
    ds_read_b64 v[238:239], v10 offset:11264
    s_waitcnt vmcnt(10) lgkmcnt(0)
    s_barrier
    v_mfma_f32_16x16x32_bf16 v[12:15], v[204:207], v[60:63], v[12:15]
    ds_read_b128 v[44:47], v6 offset:49152
    ds_read_b128 v[48:51], v6 offset:53248
    v_mfma_f32_16x16x32_bf16 v[16:19], v[204:207], v[64:67], v[16:19]
    ds_read_b128 v[52:55], v6 offset:57344
    v_mfma_f32_16x16x32_bf16 v[20:23], v[204:207], v[68:71], v[20:23]
    ds_read_b128 v[56:59], v6 offset:61440
    v_mfma_f32_16x16x32_bf16 v[24:27], v[204:207], v[72:75], v[24:27]
    v_mfma_f32_16x16x32_bf16 v[28:31], v[208:211], v[60:63], v[28:31]
    v_mfma_f32_16x16x32_bf16 v[32:35], v[208:211], v[64:67], v[32:35]
    v_mfma_f32_16x16x32_bf16 v[36:39], v[208:211], v[68:71], v[36:39]
    v_mfma_f32_16x16x32_bf16 v[40:43], v[208:211], v[72:75], v[40:43]
    s_waitcnt vmcnt(8) lgkmcnt(0)
    v_mfma_f32_16x16x32_bf16 v[12:15], v[212:215], v[76:79], v[12:15]
    ds_read_b128 v[60:63], v7 offset:49152
    ds_read_b128 v[64:67], v7 offset:53248
    v_lshlrev_b32 v164, 16, v224
    v_and_b32 v165, 0xffff0000, v224
    v_mfma_f32_16x16x32_bf16 v[16:19], v[212:215], v[80:83], v[16:19]
    ds_read_b128 v[68:71], v7 offset:57344
    v_lshlrev_b32 v166, 16, v225
    v_and_b32 v167, 0xffff0000, v225
    v_mfma_f32_16x16x32_bf16 v[20:23], v[212:215], v[84:87], v[20:23]
    ds_read_b128 v[72:75], v7 offset:61440
    v_lshlrev_b32 v124, 16, v226
    v_mfma_f32_16x16x32_bf16 v[24:27], v[212:215], v[88:91], v[24:27]
    v_and_b32 v125, 0xffff0000, v226
    v_lshlrev_b32 v126, 16, v227
    v_mfma_f32_16x16x32_bf16 v[28:31], v[216:219], v[76:79], v[28:31]
    v_and_b32 v127, 0xffff0000, v227
    v_lshlrev_b32 v168, 16, v228
    v_mfma_f32_16x16x32_bf16 v[32:35], v[216:219], v[80:83], v[32:35]
    v_and_b32 v169, 0xffff0000, v228
    v_mfma_f32_16x16x32_bf16 v[36:39], v[216:219], v[84:87], v[36:39]
    v_lshlrev_b32 v170, 16, v229
    v_and_b32 v171, 0xffff0000, v229
    v_mfma_f32_16x16x32_bf16 v[40:43], v[216:219], v[88:91], v[40:43]
    v_lshlrev_b32 v128, 16, v230
    s_waitcnt vmcnt(6) lgkmcnt(4)
    v_mfma_f32_16x16x32_bf16 v[12:15], v[92:95], v[44:47], v[12:15]
    ds_read_b128 v[76:79], v8 offset:49152
    ds_read_b128 v[80:83], v8 offset:53248
    v_and_b32 v129, 0xffff0000, v230
    v_lshlrev_b32 v130, 16, v231
    v_mfma_f32_16x16x32_bf16 v[16:19], v[92:95], v[48:51], v[16:19]
    ds_read_b128 v[84:87], v8 offset:57344
    v_and_b32 v131, 0xffff0000, v231
    v_lshlrev_b32 v116, 16, v232
    v_mfma_f32_16x16x32_bf16 v[20:23], v[92:95], v[52:55], v[20:23]
    ds_read_b128 v[88:91], v8 offset:61440
    v_and_b32 v117, 0xffff0000, v232
    v_mfma_f32_16x16x32_bf16 v[24:27], v[92:95], v[56:59], v[24:27]
    v_lshlrev_b32 v118, 16, v233
    v_and_b32 v119, 0xffff0000, v233
    v_mfma_f32_16x16x32_bf16 v[28:31], v[96:99], v[44:47], v[28:31]
    v_lshlrev_b32 v132, 16, v234
    v_and_b32 v133, 0xffff0000, v234
    v_mfma_f32_16x16x32_bf16 v[32:35], v[96:99], v[48:51], v[32:35]
    v_lshlrev_b32 v134, 16, v235
    v_mfma_f32_16x16x32_bf16 v[36:39], v[96:99], v[52:55], v[36:39]
    v_and_b32 v135, 0xffff0000, v235
    v_lshlrev_b32 v120, 16, v236
    v_mfma_f32_16x16x32_bf16 v[40:43], v[96:99], v[56:59], v[40:43]
    v_and_b32 v121, 0xffff0000, v236
    s_waitcnt vmcnt(4) lgkmcnt(4)
    v_mfma_f32_16x16x32_bf16 v[12:15], v[100:103], v[60:63], v[12:15]
    ds_read_b128 v[44:47], v9 offset:49152
    ds_read_b128 v[48:51], v9 offset:53248
    v_lshlrev_b32 v122, 16, v237
    v_and_b32 v123, 0xffff0000, v237
    v_mfma_f32_16x16x32_bf16 v[16:19], v[100:103], v[64:67], v[16:19]
    ds_read_b128 v[52:55], v9 offset:57344
    v_lshlrev_b32 v136, 16, v238
    v_and_b32 v137, 0xffff0000, v238
    v_mfma_f32_16x16x32_bf16 v[20:23], v[100:103], v[68:71], v[20:23]
    ds_read_b128 v[56:59], v9 offset:61440
    v_lshlrev_b32 v138, 16, v239
    v_mfma_f32_16x16x32_bf16 v[24:27], v[100:103], v[72:75], v[24:27]
    v_and_b32 v139, 0xffff0000, v239
    v_mul_f32 v140, v164, v250
    v_mfma_f32_16x16x32_bf16 v[28:31], v[104:107], v[60:63], v[28:31]
    v_mul_f32 v141, v165, v250
    v_mul_f32 v142, v166, v250
    v_mfma_f32_16x16x32_bf16 v[32:35], v[104:107], v[64:67], v[32:35]
    v_mul_f32 v143, v167, v250
    v_mfma_f32_16x16x32_bf16 v[36:39], v[104:107], v[68:71], v[36:39]
    v_mul_f32 v144, v168, v251
    v_mul_f32 v145, v169, v251
    v_mfma_f32_16x16x32_bf16 v[40:43], v[104:107], v[72:75], v[40:43]
    v_mul_f32 v146, v170, v251
    s_waitcnt vmcnt(2) lgkmcnt(4)
    v_mfma_f32_16x16x32_bf16 v[12:15], v[108:111], v[76:79], v[12:15]
    v_mul_f32 v147, v171, v251
    v_mul_f32 v172, v116, v252
    v_mfma_f32_16x16x32_bf16 v[16:19], v[108:111], v[80:83], v[16:19]
    v_mul_f32 v173, v117, v252
    v_mul_f32 v174, v118, v252
    v_mfma_f32_16x16x32_bf16 v[20:23], v[108:111], v[84:87], v[20:23]
    v_mul_f32 v175, v119, v252
    v_mfma_f32_16x16x32_bf16 v[24:27], v[108:111], v[88:91], v[24:27]
    v_mul_f32 v176, v120, v253
    v_mul_f32 v177, v121, v253
    v_mfma_f32_16x16x32_bf16 v[28:31], v[112:115], v[76:79], v[28:31]
    v_mul_f32 v178, v122, v253
    v_mul_f32 v179, v123, v253
    v_mfma_f32_16x16x32_bf16 v[32:35], v[112:115], v[80:83], v[32:35]
    v_mul_f32 v180, v124, v250
    v_mfma_f32_16x16x32_bf16 v[36:39], v[112:115], v[84:87], v[36:39]
    v_mul_f32 v181, v125, v250
    v_mul_f32 v182, v126, v250
    v_mfma_f32_16x16x32_bf16 v[40:43], v[112:115], v[88:91], v[40:43]
    v_mul_f32 v183, v127, v250
    s_waitcnt vmcnt(0) lgkmcnt(0)
    v_mfma_f32_16x16x32_bf16 v[12:15], v[156:159], v[44:47], v[12:15]
    v_mul_f32 v184, v128, v251
    v_mul_f32 v185, v129, v251
    v_mfma_f32_16x16x32_bf16 v[16:19], v[156:159], v[48:51], v[16:19]
    v_mul_f32 v186, v130, v251
    v_mfma_f32_16x16x32_bf16 v[20:23], v[156:159], v[52:55], v[20:23]
    v_mul_f32 v187, v131, v251
    v_mul_f32 v148, v132, v252
    v_mfma_f32_16x16x32_bf16 v[24:27], v[156:159], v[56:59], v[24:27]
    v_mul_f32 v149, v133, v252
    v_mfma_f32_16x16x32_bf16 v[28:31], v[160:163], v[44:47], v[28:31]
    v_mul_f32 v150, v134, v252
    v_mul_f32 v151, v135, v252
    v_mfma_f32_16x16x32_bf16 v[32:35], v[160:163], v[48:51], v[32:35]
    v_mul_f32 v152, v136, v253
    v_mfma_f32_16x16x32_bf16 v[36:39], v[160:163], v[52:55], v[36:39]
    v_mul_f32 v153, v137, v253
    v_mul_f32 v154, v138, v253
    v_mfma_f32_16x16x32_bf16 v[40:43], v[160:163], v[56:59], v[40:43]
    v_mul_f32 v155, v139, v253
    s_lshl_b32 s20, s4, 3
    s_add_u32 s20, s20, s5
    s_mul_i32 s20, s20, 12288
    s_lshl_b32 s21, s3, 10
    s_add_u32 s20, s20, s21
    s_add_u32 s20, s20, 7340032
    v_pk_fma_f32 v[12:13], v[12:13], v[164:165], v[140:141]
    v_pk_fma_f32 v[14:15], v[14:15], v[166:167], v[142:143]
    v_pk_fma_f32 v[28:29], v[28:29], v[124:125], v[180:181]
    v_pk_fma_f32 v[30:31], v[30:31], v[126:127], v[182:183]
    v_cvt_pk_bf16_f32 v44, v12, v13
    v_cvt_pk_bf16_f32 v45, v14, v15
    v_cvt_pk_bf16_f32 v46, v28, v29
    v_cvt_pk_bf16_f32 v47, v30, v31
    s_add_u32 s21, s20, 0
    buffer_store_dwordx4 v[44:47], v220, s[16:19], s21 offen sc1
    v_pk_fma_f32 v[16:17], v[16:17], v[168:169], v[144:145]
    v_pk_fma_f32 v[18:19], v[18:19], v[170:171], v[146:147]
    v_pk_fma_f32 v[32:33], v[32:33], v[128:129], v[184:185]
    v_pk_fma_f32 v[34:35], v[34:35], v[130:131], v[186:187]
    v_cvt_pk_bf16_f32 v48, v16, v17
    v_cvt_pk_bf16_f32 v49, v18, v19
    v_cvt_pk_bf16_f32 v50, v32, v33
    v_cvt_pk_bf16_f32 v51, v34, v35
    s_add_u32 s21, s20, 3072
    buffer_store_dwordx4 v[48:51], v220, s[16:19], s21 offen sc1
    v_pk_fma_f32 v[20:21], v[20:21], v[116:117], v[172:173]
    v_pk_fma_f32 v[22:23], v[22:23], v[118:119], v[174:175]
    v_pk_fma_f32 v[36:37], v[36:37], v[132:133], v[148:149]
    v_pk_fma_f32 v[38:39], v[38:39], v[134:135], v[150:151]
    v_cvt_pk_bf16_f32 v52, v20, v21
    v_cvt_pk_bf16_f32 v53, v22, v23
    v_cvt_pk_bf16_f32 v54, v36, v37
    v_cvt_pk_bf16_f32 v55, v38, v39
    s_add_u32 s21, s20, 6144
    buffer_store_dwordx4 v[52:55], v220, s[16:19], s21 offen sc1
    v_pk_fma_f32 v[24:25], v[24:25], v[120:121], v[176:177]
    v_pk_fma_f32 v[26:27], v[26:27], v[122:123], v[178:179]
    v_pk_fma_f32 v[40:41], v[40:41], v[136:137], v[152:153]
    v_pk_fma_f32 v[42:43], v[42:43], v[138:139], v[154:155]
    v_cvt_pk_bf16_f32 v56, v24, v25
    v_cvt_pk_bf16_f32 v57, v26, v27
    v_cvt_pk_bf16_f32 v58, v40, v41
    v_cvt_pk_bf16_f32 v59, v42, v43
    s_add_u32 s21, s20, 9216
    buffer_store_dwordx4 v[56:59], v220, s[16:19], s21 offen sc1
    s_branch L_g2x
L_g2b:
    s_add_u32 s21, s69, 0
    s_and_b32 s21, s21, 15
    s_mul_i32 s21, s21, 28672
    s_add_u32 s21, s21, s63
    buffer_load_dwordx4 v[92:95], v220, s[16:19], s21 offen offset:0 sc1
    buffer_load_dwordx4 v[100:103], v221, s[16:19], s21 offen offset:0 sc1
    buffer_load_dwordx4 v[108:111], v222, s[16:19], s21 offen offset:0 sc1
    buffer_load_dwordx4 v[116:119], v223, s[16:19], s21 offen offset:0 sc1
    s_add_u32 s21, s69, 1
    s_and_b32 s21, s21, 15
    s_mul_i32 s21, s21, 28672
    s_add_u32 s21, s21, s63
    buffer_load_dwordx4 v[124:127], v220, s[16:19], s21 offen offset:0 sc1
    buffer_load_dwordx4 v[132:135], v221, s[16:19], s21 offen offset:0 sc1
    ds_read_b128 v[44:47], v6 offset:0
    ds_read_b128 v[48:51], v6 offset:4096
    ds_read_b128 v[52:55], v6 offset:8192
    ds_read_b128 v[56:59], v6 offset:12288
    ds_read_b128 v[60:63], v7 offset:0
    ds_read_b128 v[64:67], v7 offset:4096
    ds_read_b128 v[68:71], v7 offset:8192
    ds_read_b128 v[72:75], v7 offset:12288
    v_and_b32 v5, 15, v0
    s_lshl_b32 s20, s60, 4
    v_add_u32 v5, s20, v5
    v_lshlrev_b32 v5, 2, v5
    s_lshl_b32 s20, s4, 8
    s_add_u32 s20, s20, 16384
    buffer_load_dword v254, v5, s[16:19], s20 offen sc1
    s_waitcnt vmcnt(6) lgkmcnt(4)
    v_mfma_f32_16x16x32_bf16 v[12:15], v[92:95], v[44:47], 0
    ds_read_b128 v[76:79], v8 offset:0
    ds_read_b128 v[80:83], v8 offset:4096
    v_mfma_f32_16x16x32_bf16 v[16:19], v[92:95], v[48:51], 0
    ds_read_b128 v[84:87], v8 offset:8192
    ds_read_b128 v[88:91], v8 offset:12288
    buffer_load_dwordx4 v[140:143], v222, s[16:19], s21 offen offset:0 sc1
    v_mfma_f32_16x16x32_bf16 v[20:23], v[92:95], v[52:55], 0
    buffer_load_dwordx4 v[148:151], v223, s[16:19], s21 offen offset:0 sc1
    v_mfma_f32_16x16x32_bf16 v[24:27], v[92:95], v[56:59], 0
    s_waitcnt vmcnt(7) lgkmcnt(4)
    v_mfma_f32_16x16x32_bf16 v[12:15], v[100:103], v[60:63], v[12:15]
    ds_read_b128 v[44:47], v9 offset:0
    ds_read_b128 v[48:51], v9 offset:4096
    v_mfma_f32_16x16x32_bf16 v[16:19], v[100:103], v[64:67], v[16:19]
    ds_read_b128 v[52:55], v9 offset:8192
    ds_read_b128 v[56:59], v9 offset:12288
    s_add_u32 s21, s69, 2
    s_and_b32 s21, s21, 15
    s_mul_i32 s21, s21, 28672
    s_add_u32 s21, s21, s63
    buffer_load_dwordx4 v[188:191], v220, s[16:19], s21 offen offset:0 sc1
    v_mfma_f32_16x16x32_bf16 v[20:23], v[100:103], v[68:71], v[20:23]
    buffer_load_dwordx4 v[196:199], v221, s[16:19], s21 offen offset:0 sc1
    v_mfma_f32_16x16x32_bf16 v[24:27], v[100:103], v[72:75], v[24:27]
    s_waitcnt vmcnt(8) lgkmcnt(0)
    s_barrier
    ds_write_b128 v246, v[156:159] offset:0
    ds_write_b128 v246, v[160:163] offset:1024
    ds_write_b128 v246, v[164:167] offset:2048
    ds_write_b128 v246, v[168:171] offset:3072
    v_mfma_f32_16x16x32_bf16 v[12:15], v[108:111], v[76:79], v[12:15]
    ds_read_b128 v[60:63], v6 offset:16384
    ds_read_b128 v[64:67], v6 offset:20480
    v_mfma_f32_16x16x32_bf16 v[16:19], v[108:111], v[80:83], v[16:19]
    ds_read_b128 v[68:71], v6 offset:24576
    ds_read_b128 v[72:75], v6 offset:28672
    buffer_load_dwordx4 v[204:207], v222, s[16:19], s21 offen offset:0 sc1
    v_mfma_f32_16x16x32_bf16 v[20:23], v[108:111], v[84:87], v[20:23]
    buffer_load_dwordx4 v[212:215], v223, s[16:19], s21 offen offset:0 sc1
    v_mfma_f32_16x16x32_bf16 v[24:27], v[108:111], v[88:91], v[24:27]
    s_waitcnt vmcnt(9) lgkmcnt(4)
    v_mfma_f32_16x16x32_bf16 v[12:15], v[116:119], v[44:47], v[12:15]
    ds_read_b128 v[76:79], v7 offset:16384
    ds_read_b128 v[80:83], v7 offset:20480
    v_mfma_f32_16x16x32_bf16 v[16:19], v[116:119], v[48:51], v[16:19]
    ds_read_b128 v[84:87], v7 offset:24576
    ds_read_b128 v[88:91], v7 offset:28672
    s_add_u32 s21, s69, 3
    s_and_b32 s21, s21, 15
    s_mul_i32 s21, s21, 28672
    s_add_u32 s21, s21, s63
    buffer_load_dwordx4 v[92:95], v220, s[16:19], s21 offen offset:0 sc1
    v_mfma_f32_16x16x32_bf16 v[20:23], v[116:119], v[52:55], v[20:23]
    buffer_load_dwordx4 v[100:103], v221, s[16:19], s21 offen offset:0 sc1
    v_mfma_f32_16x16x32_bf16 v[24:27], v[116:119], v[56:59], v[24:27]
    s_waitcnt vmcnt(10) lgkmcnt(4)
    v_mfma_f32_16x16x32_bf16 v[12:15], v[124:127], v[60:63], v[12:15]
    ds_read_b128 v[44:47], v8 offset:16384
    ds_read_b128 v[48:51], v8 offset:20480
    v_mfma_f32_16x16x32_bf16 v[16:19], v[124:127], v[64:67], v[16:19]
    ds_read_b128 v[52:55], v8 offset:24576
    ds_read_b128 v[56:59], v8 offset:28672
    buffer_load_dwordx4 v[108:111], v222, s[16:19], s21 offen offset:0 sc1
    v_mfma_f32_16x16x32_bf16 v[20:23], v[124:127], v[68:71], v[20:23]
    buffer_load_dwordx4 v[156:159], v223, s[16:19], s21 offen offset:0 sc1
    v_mfma_f32_16x16x32_bf16 v[24:27], v[124:127], v[72:75], v[24:27]
    s_waitcnt vmcnt(11) lgkmcnt(4)
    v_mfma_f32_16x16x32_bf16 v[12:15], v[132:135], v[76:79], v[12:15]
    ds_read_b128 v[60:63], v9 offset:16384
    ds_read_b128 v[64:67], v9 offset:20480
    v_mfma_f32_16x16x32_bf16 v[16:19], v[132:135], v[80:83], v[16:19]
    ds_read_b128 v[68:71], v9 offset:24576
    ds_read_b128 v[72:75], v9 offset:28672
    s_add_u32 s21, s69, 4
    s_and_b32 s21, s21, 15
    s_mul_i32 s21, s21, 28672
    s_add_u32 s21, s21, s63
    buffer_load_dwordx4 v[164:167], v220, s[16:19], s21 offen offset:0 sc1
    v_mfma_f32_16x16x32_bf16 v[20:23], v[132:135], v[84:87], v[20:23]
    buffer_load_dwordx4 v[116:119], v221, s[16:19], s21 offen offset:0 sc1
    v_mfma_f32_16x16x32_bf16 v[24:27], v[132:135], v[88:91], v[24:27]
    s_waitcnt vmcnt(11) lgkmcnt(0)
    s_barrier
    ds_write_b128 v246, v[172:175] offset:16384
    ds_write_b128 v246, v[176:179] offset:17408
    ds_write_b128 v246, v[180:183] offset:18432
    ds_write_b128 v246, v[184:187] offset:19456
    v_mfma_f32_16x16x32_bf16 v[12:15], v[140:143], v[44:47], v[12:15]
    ds_read_b128 v[76:79], v6 offset:32768
    ds_read_b128 v[80:83], v6 offset:36864
    v_mfma_f32_16x16x32_bf16 v[16:19], v[140:143], v[48:51], v[16:19]
    ds_read_b128 v[84:87], v6 offset:40960
    ds_read_b128 v[88:91], v6 offset:45056
    buffer_load_dwordx4 v[124:127], v222, s[16:19], s21 offen offset:0 sc1
    v_mfma_f32_16x16x32_bf16 v[20:23], v[140:143], v[52:55], v[20:23]
    buffer_load_dwordx4 v[132:135], v223, s[16:19], s21 offen offset:0 sc1
    v_mfma_f32_16x16x32_bf16 v[24:27], v[140:143], v[56:59], v[24:27]
    s_waitcnt vmcnt(12) lgkmcnt(4)
    v_mfma_f32_16x16x32_bf16 v[12:15], v[148:151], v[60:63], v[12:15]
    ds_read_b128 v[44:47], v7 offset:32768
    ds_read_b128 v[48:51], v7 offset:36864
    v_mfma_f32_16x16x32_bf16 v[16:19], v[148:151], v[64:67], v[16:19]
    ds_read_b128 v[52:55], v7 offset:40960
    ds_read_b128 v[56:59], v7 offset:45056
    s_add_u32 s21, s69, 5
    s_and_b32 s21, s21, 15
    s_mul_i32 s21, s21, 28672
    s_add_u32 s21, s21, s63
    buffer_load_dwordx4 v[140:143], v220, s[16:19], s21 offen offset:0 sc1
    v_mfma_f32_16x16x32_bf16 v[20:23], v[148:151], v[68:71], v[20:23]
    buffer_load_dwordx4 v[172:175], v221, s[16:19], s21 offen offset:0 sc1
    v_mfma_f32_16x16x32_bf16 v[24:27], v[148:151], v[72:75], v[24:27]
    s_waitcnt vmcnt(13) lgkmcnt(4)
    v_mfma_f32_16x16x32_bf16 v[12:15], v[188:191], v[76:79], v[12:15]
    ds_read_b128 v[60:63], v8 offset:32768
    ds_read_b128 v[64:67], v8 offset:36864
    v_mfma_f32_16x16x32_bf16 v[16:19], v[188:191], v[80:83], v[16:19]
    ds_read_b128 v[68:71], v8 offset:40960
    ds_read_b128 v[72:75], v8 offset:45056
    buffer_load_dwordx4 v[180:183], v222, s[16:19], s21 offen offset:0 sc1
    v_mfma_f32_16x16x32_bf16 v[20:23], v[188:191], v[84:87], v[20:23]
    buffer_load_dwordx4 v[148:151], v223, s[16:19], s21 offen offset:0 sc1
    v_mfma_f32_16x16x32_bf16 v[24:27], v[188:191], v[88:91], v[24:27]
    s_waitcnt vmcnt(14) lgkmcnt(4)
    v_mfma_f32_16x16x32_bf16 v[12:15], v[196:199], v[44:47], v[12:15]
    ds_read_b128 v[76:79], v9 offset:32768
    ds_read_b128 v[80:83], v9 offset:36864
    v_mfma_f32_16x16x32_bf16 v[16:19], v[196:199], v[48:51], v[16:19]
    ds_read_b128 v[84:87], v9 offset:40960
    ds_read_b128 v[88:91], v9 offset:45056
    s_add_u32 s21, s69, 6
    s_and_b32 s21, s21, 15
    s_mul_i32 s21, s21, 28672
    s_add_u32 s21, s21, s63
    buffer_load_dwordx4 v[188:191], v220, s[16:19], s21 offen offset:0 sc1
    v_mfma_f32_16x16x32_bf16 v[20:23], v[196:199], v[52:55], v[20:23]
    v_mfma_f32_16x16x32_bf16 v[24:27], v[196:199], v[56:59], v[24:27]
    s_waitcnt vmcnt(14) lgkmcnt(0)
    s_barrier
    v_mfma_f32_16x16x32_bf16 v[12:15], v[204:207], v[60:63], v[12:15]
    ds_read_b128 v[44:47], v6 offset:49152
    ds_read_b128 v[48:51], v6 offset:53248
    v_mfma_f32_16x16x32_bf16 v[16:19], v[204:207], v[64:67], v[16:19]
    ds_read_b128 v[52:55], v6 offset:57344
    ds_read_b128 v[56:59], v6 offset:61440
    s_add_u32 s22, s69, 6
    s_and_b32 s22, s22, 15
    s_lshl_b32 s23, s22, 8
    s_add_u32 s23, s23, s61
    s_add_u32 m0, s62, 114688
    s_nop 0
    buffer_load_dwordx4 v1, s[8:11], s23 offen lds
    v_mfma_f32_16x16x32_bf16 v[20:23], v[204:207], v[68:71], v[20:23]
    s_add_u32 m0, s62, 115712
    s_nop 0
    buffer_load_dwordx4 v2, s[8:11], s23 offen lds
    v_mfma_f32_16x16x32_bf16 v[24:27], v[204:207], v[72:75], v[24:27]
    s_waitcnt vmcnt(15) lgkmcnt(4)
    v_mfma_f32_16x16x32_bf16 v[12:15], v[212:215], v[76:79], v[12:15]
    ds_read_b128 v[60:63], v7 offset:49152
    ds_read_b128 v[64:67], v7 offset:53248
    v_mfma_f32_16x16x32_bf16 v[16:19], v[212:215], v[80:83], v[16:19]
    ds_read_b128 v[68:71], v7 offset:57344
    ds_read_b128 v[72:75], v7 offset:61440
    s_add_u32 m0, s62, 116736
    s_nop 0
    buffer_load_dwordx4 v3, s[8:11], s23 offen lds
    v_mfma_f32_16x16x32_bf16 v[20:23], v[212:215], v[84:87], v[20:23]
    s_add_u32 m0, s62, 117760
    s_nop 0
    buffer_load_dwordx4 v4, s[8:11], s23 offen lds
    v_mfma_f32_16x16x32_bf16 v[24:27], v[212:215], v[88:91], v[24:27]
    s_waitcnt vmcnt(16) lgkmcnt(4)
    v_mfma_f32_16x16x32_bf16 v[12:15], v[92:95], v[44:47], v[12:15]
    ds_read_b128 v[76:79], v8 offset:49152
    ds_read_b128 v[80:83], v8 offset:53248
    v_mfma_f32_16x16x32_bf16 v[16:19], v[92:95], v[48:51], v[16:19]
    ds_read_b128 v[84:87], v8 offset:57344
    ds_read_b128 v[88:91], v8 offset:61440
    buffer_load_dwordx4 v[196:199], v221, s[16:19], s21 offen offset:0 sc1
    v_mfma_f32_16x16x32_bf16 v[20:23], v[92:95], v[52:55], v[20:23]
    buffer_load_dwordx4 v[204:207], v222, s[16:19], s21 offen offset:0 sc1
    v_mfma_f32_16x16x32_bf16 v[24:27], v[92:95], v[56:59], v[24:27]
    s_waitcnt vmcnt(17) lgkmcnt(4)
    v_mfma_f32_16x16x32_bf16 v[12:15], v[100:103], v[60:63], v[12:15]
    ds_read_b128 v[44:47], v9 offset:49152
    ds_read_b128 v[48:51], v9 offset:53248
    v_mfma_f32_16x16x32_bf16 v[16:19], v[100:103], v[64:67], v[16:19]
    ds_read_b128 v[52:55], v9 offset:57344
    ds_read_b128 v[56:59], v9 offset:61440
    buffer_load_dwordx4 v[212:215], v223, s[16:19], s21 offen offset:0 sc1
    v_mfma_f32_16x16x32_bf16 v[20:23], v[100:103], v[68:71], v[20:23]
    s_add_u32 s21, s69, 7
    s_and_b32 s21, s21, 15
    s_mul_i32 s21, s21, 28672
    s_add_u32 s21, s21, s63
    buffer_load_dwordx4 v[92:95], v220, s[16:19], s21 offen offset:0 sc1
    v_mfma_f32_16x16x32_bf16 v[24:27], v[100:103], v[72:75], v[24:27]
    s_waitcnt vmcnt(18) lgkmcnt(0)
    s_barrier
    v_mfma_f32_16x16x32_bf16 v[12:15], v[108:111], v[76:79], v[12:15]
    ds_read_b128 v[60:63], v6 offset:0
    ds_read_b128 v[64:67], v6 offset:4096
    v_mfma_f32_16x16x32_bf16 v[16:19], v[108:111], v[80:83], v[16:19]
    ds_read_b128 v[68:71], v6 offset:8192
    ds_read_b128 v[72:75], v6 offset:12288
    s_add_u32 s22, s69, 7
    s_and_b32 s22, s22, 15
    s_lshl_b32 s23, s22, 8
    s_add_u32 s23, s23, s61
    s_add_u32 m0, s62, 131072
    s_nop 0
    buffer_load_dwordx4 v1, s[8:11], s23 offen lds
    v_mfma_f32_16x16x32_bf16 v[20:23], v[108:111], v[84:87], v[20:23]
    s_add_u32 m0, s62, 132096
    s_nop 0
    buffer_load_dwordx4 v2, s[8:11], s23 offen lds
    v_mfma_f32_16x16x32_bf16 v[24:27], v[108:111], v[88:91], v[24:27]
    s_waitcnt vmcnt(19) lgkmcnt(4)
    v_mfma_f32_16x16x32_bf16 v[12:15], v[156:159], v[44:47], v[12:15]
    ds_read_b128 v[76:79], v7 offset:0
    ds_read_b128 v[80:83], v7 offset:4096
    v_mfma_f32_16x16x32_bf16 v[16:19], v[156:159], v[48:51], v[16:19]
    ds_read_b128 v[84:87], v7 offset:8192
    ds_read_b128 v[88:91], v7 offset:12288
    s_add_u32 m0, s62, 133120
    s_nop 0
    buffer_load_dwordx4 v3, s[8:11], s23 offen lds
    v_mfma_f32_16x16x32_bf16 v[20:23], v[156:159], v[52:55], v[20:23]
    s_add_u32 m0, s62, 134144
    s_nop 0
    buffer_load_dwordx4 v4, s[8:11], s23 offen lds
    v_mfma_f32_16x16x32_bf16 v[24:27], v[156:159], v[56:59], v[24:27]
    s_waitcnt vmcnt(20) lgkmcnt(4)
    v_mfma_f32_16x16x32_bf16 v[12:15], v[164:167], v[60:63], v[12:15]
    ds_read_b128 v[44:47], v8 offset:0
    ds_read_b128 v[48:51], v8 offset:4096
    v_mfma_f32_16x16x32_bf16 v[16:19], v[164:167], v[64:67], v[16:19]
    ds_read_b128 v[52:55], v8 offset:8192
    ds_read_b128 v[56:59], v8 offset:12288
    buffer_load_dwordx4 v[100:103], v221, s[16:19], s21 offen offset:0 sc1
    v_mfma_f32_16x16x32_bf16 v[20:23], v[164:167], v[68:71], v[20:23]
    buffer_load_dwordx4 v[108:111], v222, s[16:19], s21 offen offset:0 sc1
    v_mfma_f32_16x16x32_bf16 v[24:27], v[164:167], v[72:75], v[24:27]
    s_waitcnt vmcnt(21) lgkmcnt(4)
    v_mfma_f32_16x16x32_bf16 v[12:15], v[116:119], v[76:79], v[12:15]
    ds_read_b128 v[60:63], v9 offset:0
    ds_read_b128 v[64:67], v9 offset:4096
    v_mfma_f32_16x16x32_bf16 v[16:19], v[116:119], v[80:83], v[16:19]
    ds_read_b128 v[68:71], v9 offset:8192
    ds_read_b128 v[72:75], v9 offset:12288
    buffer_load_dwordx4 v[156:159], v223, s[16:19], s21 offen offset:0 sc1
    v_mfma_f32_16x16x32_bf16 v[20:23], v[116:119], v[84:87], v[20:23]
    s_add_u32 s21, s69, 8
    s_and_b32 s21, s21, 15
    s_mul_i32 s21, s21, 28672
    s_add_u32 s21, s21, s63
    buffer_load_dwordx4 v[164:167], v220, s[16:19], s21 offen offset:0 sc1
    v_mfma_f32_16x16x32_bf16 v[24:27], v[116:119], v[88:91], v[24:27]
    s_waitcnt vmcnt(22) lgkmcnt(0)
    s_barrier
    v_mfma_f32_16x16x32_bf16 v[12:15], v[124:127], v[44:47], v[12:15]
    ds_read_b128 v[76:79], v6 offset:16384
    ds_read_b128 v[80:83], v6 offset:20480
    v_mfma_f32_16x16x32_bf16 v[16:19], v[124:127], v[48:51], v[16:19]
    ds_read_b128 v[84:87], v6 offset:24576
    ds_read_b128 v[88:91], v6 offset:28672
    s_add_u32 s22, s69, 8
    s_and_b32 s22, s22, 15
    s_lshl_b32 s23, s22, 8
    s_add_u32 s23, s23, s61
    s_add_u32 m0, s62, 81920
    s_nop 0
    buffer_load_dwordx4 v1, s[8:11], s23 offen lds
    v_mfma_f32_16x16x32_bf16 v[20:23], v[124:127], v[52:55], v[20:23]
    s_add_u32 m0, s62, 82944
    s_nop 0
    buffer_load_dwordx4 v2, s[8:11], s23 offen lds
    v_mfma_f32_16x16x32_bf16 v[24:27], v[124:127], v[56:59], v[24:27]
    s_waitcnt vmcnt(23) lgkmcnt(4)
    v_mfma_f32_16x16x32_bf16 v[12:15], v[132:135], v[60:63], v[12:15]
    ds_read_b128 v[44:47], v7 offset:16384
    ds_read_b128 v[48:51], v7 offset:20480
    v_mfma_f32_16x16x32_bf16 v[16:19], v[132:135], v[64:67], v[16:19]
    ds_read_b128 v[52:55], v7 offset:24576
    ds_read_b128 v[56:59], v7 offset:28672
    s_add_u32 m0, s62, 83968
    s_nop 0
    buffer_load_dwordx4 v3, s[8:11], s23 offen lds
    v_mfma_f32_16x16x32_bf16 v[20:23], v[132:135], v[68:71], v[20:23]
    s_add_u32 m0, s62, 84992
    s_nop 0
    buffer_load_dwordx4 v4, s[8:11], s23 offen lds
    v_mfma_f32_16x16x32_bf16 v[24:27], v[132:135], v[72:75], v[24:27]
    s_waitcnt vmcnt(24) lgkmcnt(4)
    v_mfma_f32_16x16x32_bf16 v[12:15], v[140:143], v[76:79], v[12:15]
    ds_read_b128 v[60:63], v8 offset:16384
    ds_read_b128 v[64:67], v8 offset:20480
    v_mfma_f32_16x16x32_bf16 v[16:19], v[140:143], v[80:83], v[16:19]
    ds_read_b128 v[68:71], v8 offset:24576
    ds_read_b128 v[72:75], v8 offset:28672
    buffer_load_dwordx4 v[116:119], v221, s[16:19], s21 offen offset:0 sc1
    v_mfma_f32_16x16x32_bf16 v[20:23], v[140:143], v[84:87], v[20:23]
    buffer_load_dwordx4 v[124:127], v222, s[16:19], s21 offen offset:0 sc1
    v_mfma_f32_16x16x32_bf16 v[24:27], v[140:143], v[88:91], v[24:27]
    s_waitcnt vmcnt(25) lgkmcnt(4)
    v_mfma_f32_16x16x32_bf16 v[12:15], v[172:175], v[44:47], v[12:15]
    ds_read_b128 v[76:79], v9 offset:16384
    ds_read_b128 v[80:83], v9 offset:20480
    v_mfma_f32_16x16x32_bf16 v[16:19], v[172:175], v[48:51], v[16:19]
    ds_read_b128 v[84:87], v9 offset:24576
    ds_read_b128 v[88:91], v9 offset:28672
    buffer_load_dwordx4 v[132:135], v223, s[16:19], s21 offen offset:0 sc1
    v_mfma_f32_16x16x32_bf16 v[20:23], v[172:175], v[52:55], v[20:23]
    s_add_u32 s21, s69, 9
    s_and_b32 s21, s21, 15
    s_mul_i32 s21, s21, 28672
    s_add_u32 s21, s21, s63
    buffer_load_dwordx4 v[140:143], v220, s[16:19], s21 offen offset:0 sc1
    v_mfma_f32_16x16x32_bf16 v[24:27], v[172:175], v[56:59], v[24:27]
    s_waitcnt vmcnt(20) lgkmcnt(0)
    s_barrier
    v_mfma_f32_16x16x32_bf16 v[12:15], v[180:183], v[60:63], v[12:15]
    ds_read_b128 v[44:47], v6 offset:32768
    ds_read_b128 v[48:51], v6 offset:36864
    v_mfma_f32_16x16x32_bf16 v[16:19], v[180:183], v[64:67], v[16:19]
    ds_read_b128 v[52:55], v6 offset:40960
    ds_read_b128 v[56:59], v6 offset:45056
    s_add_u32 s22, s69, 9
    s_and_b32 s22, s22, 15
    s_lshl_b32 s23, s22, 8
    s_add_u32 s23, s23, s61
    s_add_u32 m0, s62, 98304
    s_nop 0
    buffer_load_dwordx4 v1, s[8:11], s23 offen lds
    v_mfma_f32_16x16x32_bf16 v[20:23], v[180:183], v[68:71], v[20:23]
    s_add_u32 m0, s62, 99328
    s_nop 0
    buffer_load_dwordx4 v2, s[8:11], s23 offen lds
    v_mfma_f32_16x16x32_bf16 v[24:27], v[180:183], v[72:75], v[24:27]
    s_waitcnt vmcnt(27) lgkmcnt(4)
    v_mfma_f32_16x16x32_bf16 v[12:15], v[148:151], v[76:79], v[12:15]
    ds_read_b128 v[60:63], v7 offset:32768
    ds_read_b128 v[64:67], v7 offset:36864
    v_mfma_f32_16x16x32_bf16 v[16:19], v[148:151], v[80:83], v[16:19]
    ds_read_b128 v[68:71], v7 offset:40960
    ds_read_b128 v[72:75], v7 offset:45056
    s_add_u32 m0, s62, 100352
    s_nop 0
    buffer_load_dwordx4 v3, s[8:11], s23 offen lds
    v_mfma_f32_16x16x32_bf16 v[20:23], v[148:151], v[84:87], v[20:23]
    s_add_u32 m0, s62, 101376
    s_nop 0
    buffer_load_dwordx4 v4, s[8:11], s23 offen lds
    v_mfma_f32_16x16x32_bf16 v[24:27], v[148:151], v[88:91], v[24:27]
    s_waitcnt vmcnt(28) lgkmcnt(4)
    v_mfma_f32_16x16x32_bf16 v[12:15], v[188:191], v[44:47], v[12:15]
    ds_read_b128 v[76:79], v8 offset:32768
    ds_read_b128 v[80:83], v8 offset:36864
    v_mfma_f32_16x16x32_bf16 v[16:19], v[188:191], v[48:51], v[16:19]
    ds_read_b128 v[84:87], v8 offset:40960
    ds_read_b128 v[88:91], v8 offset:45056
    buffer_load_dwordx4 v[172:175], v221, s[16:19], s21 offen offset:0 sc1
    v_mfma_f32_16x16x32_bf16 v[20:23], v[188:191], v[52:55], v[20:23]
    buffer_load_dwordx4 v[180:183], v222, s[16:19], s21 offen offset:0 sc1
    v_mfma_f32_16x16x32_bf16 v[24:27], v[188:191], v[56:59], v[24:27]
    s_waitcnt vmcnt(25) lgkmcnt(4)
    v_mfma_f32_16x16x32_bf16 v[12:15], v[196:199], v[60:63], v[12:15]
    ds_read_b128 v[44:47], v9 offset:32768
    ds_read_b128 v[48:51], v9 offset:36864
    v_mfma_f32_16x16x32_bf16 v[16:19], v[196:199], v[64:67], v[16:19]
    ds_read_b128 v[52:55], v9 offset:40960
    ds_read_b128 v[56:59], v9 offset:45056
    buffer_load_dwordx4 v[148:151], v223, s[16:19], s21 offen offset:0 sc1
    v_mfma_f32_16x16x32_bf16 v[20:23], v[196:199], v[68:71], v[20:23]
    s_add_u32 s21, s69, 10
    s_and_b32 s21, s21, 15
    s_mul_i32 s21, s21, 28672
    s_add_u32 s21, s21, s63
    buffer_load_dwordx4 v[188:191], v220, s[16:19], s21 offen offset:0 sc1
    v_mfma_f32_16x16x32_bf16 v[24:27], v[196:199], v[72:75], v[24:27]
    s_waitcnt vmcnt(20) lgkmcnt(0)
    s_barrier
    v_mfma_f32_16x16x32_bf16 v[12:15], v[204:207], v[76:79], v[12:15]
    ds_read_b128 v[60:63], v6 offset:49152
    ds_read_b128 v[64:67], v6 offset:53248
    v_mfma_f32_16x16x32_bf16 v[16:19], v[204:207], v[80:83], v[16:19]
    ds_read_b128 v[68:71], v6 offset:57344
    ds_read_b128 v[72:75], v6 offset:61440
    s_add_u32 s22, s69, 10
    s_and_b32 s22, s22, 15
    s_lshl_b32 s23, s22, 8
    s_add_u32 s23, s23, s61
    s_add_u32 m0, s62, 114688
    s_nop 0
    buffer_load_dwordx4 v1, s[8:11], s23 offen lds
    v_mfma_f32_16x16x32_bf16 v[20:23], v[204:207], v[84:87], v[20:23]
    s_add_u32 m0, s62, 115712
    s_nop 0
    buffer_load_dwordx4 v2, s[8:11], s23 offen lds
    v_mfma_f32_16x16x32_bf16 v[24:27], v[204:207], v[88:91], v[24:27]
    s_waitcnt vmcnt(27) lgkmcnt(4)
    v_mfma_f32_16x16x32_bf16 v[12:15], v[212:215], v[44:47], v[12:15]
    ds_read_b128 v[76:79], v7 offset:49152
    ds_read_b128 v[80:83], v7 offset:53248
    v_mfma_f32_16x16x32_bf16 v[16:19], v[212:215], v[48:51], v[16:19]
    ds_read_b128 v[84:87], v7 offset:57344
    ds_read_b128 v[88:91], v7 offset:61440
    s_add_u32 m0, s62, 116736
    s_nop 0
    buffer_load_dwordx4 v3, s[8:11], s23 offen lds
    v_mfma_f32_16x16x32_bf16 v[20:23], v[212:215], v[52:55], v[20:23]
    s_add_u32 m0, s62, 117760
    s_nop 0
    buffer_load_dwordx4 v4, s[8:11], s23 offen lds
    v_mfma_f32_16x16x32_bf16 v[24:27], v[212:215], v[56:59], v[24:27]
    s_waitcnt vmcnt(28) lgkmcnt(4)
    v_mfma_f32_16x16x32_bf16 v[12:15], v[92:95], v[60:63], v[12:15]
    ds_read_b128 v[44:47], v8 offset:49152
    ds_read_b128 v[48:51], v8 offset:53248
    v_mfma_f32_16x16x32_bf16 v[16:19], v[92:95], v[64:67], v[16:19]
    ds_read_b128 v[52:55], v8 offset:57344
    ds_read_b128 v[56:59], v8 offset:61440
    buffer_load_dwordx4 v[196:199], v221, s[16:19], s21 offen offset:0 sc1
    v_mfma_f32_16x16x32_bf16 v[20:23], v[92:95], v[68:71], v[20:23]
    buffer_load_dwordx4 v[204:207], v222, s[16:19], s21 offen offset:0 sc1
    v_mfma_f32_16x16x32_bf16 v[24:27], v[92:95], v[72:75], v[24:27]
    s_waitcnt vmcnt(25) lgkmcnt(4)
    v_mfma_f32_16x16x32_bf16 v[12:15], v[100:103], v[76:79], v[12:15]
    ds_read_b128 v[60:63], v9 offset:49152
    ds_read_b128 v[64:67], v9 offset:53248
    v_mfma_f32_16x16x32_bf16 v[16:19], v[100:103], v[80:83], v[16:19]
    ds_read_b128 v[68:71], v9 offset:57344
    ds_read_b128 v[72:75], v9 offset:61440
    buffer_load_dwordx4 v[212:215], v223, s[16:19], s21 offen offset:0 sc1
    v_mfma_f32_16x16x32_bf16 v[20:23], v[100:103], v[84:87], v[20:23]
    s_add_u32 s21, s69, 11
    s_and_b32 s21, s21, 15
    s_mul_i32 s21, s21, 28672
    s_add_u32 s21, s21, s63
    buffer_load_dwordx4 v[92:95], v220, s[16:19], s21 offen offset:0 sc1
    v_mfma_f32_16x16x32_bf16 v[24:27], v[100:103], v[88:91], v[24:27]
    s_waitcnt vmcnt(20) lgkmcnt(0)
    s_barrier
    v_mfma_f32_16x16x32_bf16 v[12:15], v[108:111], v[44:47], v[12:15]
    ds_read_b128 v[76:79], v6 offset:0
    ds_read_b128 v[80:83], v6 offset:4096
    v_mfma_f32_16x16x32_bf16 v[16:19], v[108:111], v[48:51], v[16:19]
    ds_read_b128 v[84:87], v6 offset:8192
    ds_read_b128 v[88:91], v6 offset:12288
    s_add_u32 s22, s69, 11
    s_and_b32 s22, s22, 15
    s_lshl_b32 s23, s22, 8
    s_add_u32 s23, s23, s61
    s_add_u32 m0, s62, 131072
    s_nop 0
    buffer_load_dwordx4 v1, s[8:11], s23 offen lds
    v_mfma_f32_16x16x32_bf16 v[20:23], v[108:111], v[52:55], v[20:23]
    s_add_u32 m0, s62, 132096
    s_nop 0
    buffer_load_dwordx4 v2, s[8:11], s23 offen lds
    v_mfma_f32_16x16x32_bf16 v[24:27], v[108:111], v[56:59], v[24:27]
    s_waitcnt vmcnt(27) lgkmcnt(4)
    v_mfma_f32_16x16x32_bf16 v[12:15], v[156:159], v[60:63], v[12:15]
    ds_read_b128 v[44:47], v7 offset:0
    ds_read_b128 v[48:51], v7 offset:4096
    v_mfma_f32_16x16x32_bf16 v[16:19], v[156:159], v[64:67], v[16:19]
    ds_read_b128 v[52:55], v7 offset:8192
    ds_read_b128 v[56:59], v7 offset:12288
    s_add_u32 m0, s62, 133120
    s_nop 0
    buffer_load_dwordx4 v3, s[8:11], s23 offen lds
    v_mfma_f32_16x16x32_bf16 v[20:23], v[156:159], v[68:71], v[20:23]
    s_add_u32 m0, s62, 134144
    s_nop 0
    buffer_load_dwordx4 v4, s[8:11], s23 offen lds
    v_mfma_f32_16x16x32_bf16 v[24:27], v[156:159], v[72:75], v[24:27]
    s_waitcnt vmcnt(28) lgkmcnt(4)
    v_mfma_f32_16x16x32_bf16 v[12:15], v[164:167], v[76:79], v[12:15]
    ds_read_b128 v[60:63], v8 offset:0
    ds_read_b128 v[64:67], v8 offset:4096
    v_mfma_f32_16x16x32_bf16 v[16:19], v[164:167], v[80:83], v[16:19]
    ds_read_b128 v[68:71], v8 offset:8192
    ds_read_b128 v[72:75], v8 offset:12288
    buffer_load_dwordx4 v[100:103], v221, s[16:19], s21 offen offset:0 sc1
    v_mfma_f32_16x16x32_bf16 v[20:23], v[164:167], v[84:87], v[20:23]
    buffer_load_dwordx4 v[108:111], v222, s[16:19], s21 offen offset:0 sc1
    v_mfma_f32_16x16x32_bf16 v[24:27], v[164:167], v[88:91], v[24:27]
    s_waitcnt vmcnt(25) lgkmcnt(4)
    v_mfma_f32_16x16x32_bf16 v[12:15], v[116:119], v[44:47], v[12:15]
    ds_read_b128 v[76:79], v9 offset:0
    ds_read_b128 v[80:83], v9 offset:4096
    v_mfma_f32_16x16x32_bf16 v[16:19], v[116:119], v[48:51], v[16:19]
    ds_read_b128 v[84:87], v9 offset:8192
    ds_read_b128 v[88:91], v9 offset:12288
    buffer_load_dwordx4 v[156:159], v223, s[16:19], s21 offen offset:0 sc1
    v_mfma_f32_16x16x32_bf16 v[20:23], v[116:119], v[52:55], v[20:23]
    s_add_u32 s21, s69, 12
    s_and_b32 s21, s21, 15
    s_mul_i32 s21, s21, 28672
    s_add_u32 s21, s21, s63
    buffer_load_dwordx4 v[164:167], v220, s[16:19], s21 offen offset:0 sc1
    v_mfma_f32_16x16x32_bf16 v[24:27], v[116:119], v[56:59], v[24:27]
    s_waitcnt vmcnt(20) lgkmcnt(0)
    s_barrier
    v_mfma_f32_16x16x32_bf16 v[12:15], v[124:127], v[60:63], v[12:15]
    ds_read_b128 v[44:47], v6 offset:16384
    ds_read_b128 v[48:51], v6 offset:20480
    v_mfma_f32_16x16x32_bf16 v[16:19], v[124:127], v[64:67], v[16:19]
    ds_read_b128 v[52:55], v6 offset:24576
    ds_read_b128 v[56:59], v6 offset:28672
    s_add_u32 s22, s69, 12
    s_and_b32 s22, s22, 15
    s_lshl_b32 s23, s22, 8
    s_add_u32 s23, s23, s61
    s_add_u32 m0, s62, 81920
    s_nop 0
    buffer_load_dwordx4 v1, s[8:11], s23 offen lds
    v_mfma_f32_16x16x32_bf16 v[20:23], v[124:127], v[68:71], v[20:23]
    s_add_u32 m0, s62, 82944
    s_nop 0
    buffer_load_dwordx4 v2, s[8:11], s23 offen lds
    v_mfma_f32_16x16x32_bf16 v[24:27], v[124:127], v[72:75], v[24:27]
    s_waitcnt vmcnt(27) lgkmcnt(4)
    v_mfma_f32_16x16x32_bf16 v[12:15], v[132:135], v[76:79], v[12:15]
    ds_read_b128 v[60:63], v7 offset:16384
    ds_read_b128 v[64:67], v7 offset:20480
    v_mfma_f32_16x16x32_bf16 v[16:19], v[132:135], v[80:83], v[16:19]
    ds_read_b128 v[68:71], v7 offset:24576
    ds_read_b128 v[72:75], v7 offset:28672
    s_add_u32 m0, s62, 83968
    s_nop 0
    buffer_load_dwordx4 v3, s[8:11], s23 offen lds
    v_mfma_f32_16x16x32_bf16 v[20:23], v[132:135], v[84:87], v[20:23]
    s_add_u32 m0, s62, 84992
    s_nop 0
    buffer_load_dwordx4 v4, s[8:11], s23 offen lds
    v_mfma_f32_16x16x32_bf16 v[24:27], v[132:135], v[88:91], v[24:27]
    s_waitcnt vmcnt(28) lgkmcnt(4)
    v_mfma_f32_16x16x32_bf16 v[12:15], v[140:143], v[44:47], v[12:15]
    ds_read_b128 v[76:79], v8 offset:16384
    ds_read_b128 v[80:83], v8 offset:20480
    v_mfma_f32_16x16x32_bf16 v[16:19], v[140:143], v[48:51], v[16:19]
    ds_read_b128 v[84:87], v8 offset:24576
    ds_read_b128 v[88:91], v8 offset:28672
    buffer_load_dwordx4 v[116:119], v221, s[16:19], s21 offen offset:0 sc1
    v_mfma_f32_16x16x32_bf16 v[20:23], v[140:143], v[52:55], v[20:23]
    buffer_load_dwordx4 v[124:127], v222, s[16:19], s21 offen offset:0 sc1
    v_mfma_f32_16x16x32_bf16 v[24:27], v[140:143], v[56:59], v[24:27]
    s_waitcnt vmcnt(25) lgkmcnt(4)
    v_mfma_f32_16x16x32_bf16 v[12:15], v[172:175], v[60:63], v[12:15]
    ds_read_b128 v[44:47], v9 offset:16384
    ds_read_b128 v[48:51], v9 offset:20480
    v_mfma_f32_16x16x32_bf16 v[16:19], v[172:175], v[64:67], v[16:19]
    ds_read_b128 v[52:55], v9 offset:24576
    ds_read_b128 v[56:59], v9 offset:28672
    buffer_load_dwordx4 v[132:135], v223, s[16:19], s21 offen offset:0 sc1
    v_mfma_f32_16x16x32_bf16 v[20:23], v[172:175], v[68:71], v[20:23]
    s_add_u32 s21, s69, 13
    s_and_b32 s21, s21, 15
    s_mul_i32 s21, s21, 28672
    s_add_u32 s21, s21, s63
    buffer_load_dwordx4 v[140:143], v220, s[16:19], s21 offen offset:0 sc1
    v_mfma_f32_16x16x32_bf16 v[24:27], v[172:175], v[72:75], v[24:27]
    s_waitcnt vmcnt(20) lgkmcnt(0)
    s_barrier
    v_mfma_f32_16x16x32_bf16 v[12:15], v[180:183], v[76:79], v[12:15]
    ds_read_b128 v[60:63], v6 offset:32768
    ds_read_b128 v[64:67], v6 offset:36864
    v_mfma_f32_16x16x32_bf16 v[16:19], v[180:183], v[80:83], v[16:19]
    ds_read_b128 v[68:71], v6 offset:40960
    ds_read_b128 v[72:75], v6 offset:45056
    s_add_u32 s22, s69, 13
    s_and_b32 s22, s22, 15
    s_lshl_b32 s23, s22, 8
    s_add_u32 s23, s23, s61
    s_add_u32 m0, s62, 98304
    s_nop 0
    buffer_load_dwordx4 v1, s[8:11], s23 offen lds
    v_mfma_f32_16x16x32_bf16 v[20:23], v[180:183], v[84:87], v[20:23]
    s_add_u32 m0, s62, 99328
    s_nop 0
    buffer_load_dwordx4 v2, s[8:11], s23 offen lds
    v_mfma_f32_16x16x32_bf16 v[24:27], v[180:183], v[88:91], v[24:27]
    s_waitcnt vmcnt(27) lgkmcnt(4)
    v_mfma_f32_16x16x32_bf16 v[12:15], v[148:151], v[44:47], v[12:15]
    ds_read_b128 v[76:79], v7 offset:32768
    ds_read_b128 v[80:83], v7 offset:36864
    v_mfma_f32_16x16x32_bf16 v[16:19], v[148:151], v[48:51], v[16:19]
    ds_read_b128 v[84:87], v7 offset:40960
    ds_read_b128 v[88:91], v7 offset:45056
    s_add_u32 m0, s62, 100352
    s_nop 0
    buffer_load_dwordx4 v3, s[8:11], s23 offen lds
    v_mfma_f32_16x16x32_bf16 v[20:23], v[148:151], v[52:55], v[20:23]
    s_add_u32 m0, s62, 101376
    s_nop 0
    buffer_load_dwordx4 v4, s[8:11], s23 offen lds
    v_mfma_f32_16x16x32_bf16 v[24:27], v[148:151], v[56:59], v[24:27]
    s_waitcnt vmcnt(28) lgkmcnt(4)
    v_mfma_f32_16x16x32_bf16 v[12:15], v[188:191], v[60:63], v[12:15]
    ds_read_b128 v[44:47], v8 offset:32768
    ds_read_b128 v[48:51], v8 offset:36864
    v_mfma_f32_16x16x32_bf16 v[16:19], v[188:191], v[64:67], v[16:19]
    ds_read_b128 v[52:55], v8 offset:40960
    ds_read_b128 v[56:59], v8 offset:45056
    buffer_load_dwordx4 v[172:175], v221, s[16:19], s21 offen offset:0 sc1
    v_mfma_f32_16x16x32_bf16 v[20:23], v[188:191], v[68:71], v[20:23]
    buffer_load_dwordx4 v[180:183], v222, s[16:19], s21 offen offset:0 sc1
    v_mfma_f32_16x16x32_bf16 v[24:27], v[188:191], v[72:75], v[24:27]
    s_waitcnt vmcnt(25) lgkmcnt(4)
    v_mfma_f32_16x16x32_bf16 v[12:15], v[196:199], v[76:79], v[12:15]
    ds_read_b128 v[60:63], v9 offset:32768
    ds_read_b128 v[64:67], v9 offset:36864
    v_mfma_f32_16x16x32_bf16 v[16:19], v[196:199], v[80:83], v[16:19]
    ds_read_b128 v[68:71], v9 offset:40960
    ds_read_b128 v[72:75], v9 offset:45056
    buffer_load_dwordx4 v[148:151], v223, s[16:19], s21 offen offset:0 sc1
    v_mfma_f32_16x16x32_bf16 v[20:23], v[196:199], v[84:87], v[20:23]
    s_add_u32 s21, s69, 14
    s_and_b32 s21, s21, 15
    s_mul_i32 s21, s21, 28672
    s_add_u32 s21, s21, s63
    buffer_load_dwordx4 v[188:191], v220, s[16:19], s21 offen offset:0 sc1
    v_mfma_f32_16x16x32_bf16 v[24:27], v[196:199], v[88:91], v[24:27]
    s_waitcnt vmcnt(20) lgkmcnt(0)
    s_barrier
    v_mfma_f32_16x16x32_bf16 v[12:15], v[204:207], v[44:47], v[12:15]
    ds_read_b128 v[76:79], v6 offset:49152
    ds_read_b128 v[80:83], v6 offset:53248
    v_mfma_f32_16x16x32_bf16 v[16:19], v[204:207], v[48:51], v[16:19]
    ds_read_b128 v[84:87], v6 offset:57344
    ds_read_b128 v[88:91], v6 offset:61440
    s_add_u32 s22, s69, 14
    s_and_b32 s22, s22, 15
    s_lshl_b32 s23, s22, 8
    s_add_u32 s23, s23, s61
    s_add_u32 m0, s62, 114688
    s_nop 0
    buffer_load_dwordx4 v1, s[8:11], s23 offen lds
    v_mfma_f32_16x16x32_bf16 v[20:23], v[204:207], v[52:55], v[20:23]
    s_add_u32 m0, s62, 115712
    s_nop 0
    buffer_load_dwordx4 v2, s[8:11], s23 offen lds
    v_mfma_f32_16x16x32_bf16 v[24:27], v[204:207], v[56:59], v[24:27]
    s_waitcnt vmcnt(27) lgkmcnt(4)
    v_mfma_f32_16x16x32_bf16 v[12:15], v[212:215], v[60:63], v[12:15]
    ds_read_b128 v[44:47], v7 offset:49152
    ds_read_b128 v[48:51], v7 offset:53248
    v_mfma_f32_16x16x32_bf16 v[16:19], v[212:215], v[64:67], v[16:19]
    ds_read_b128 v[52:55], v7 offset:57344
    ds_read_b128 v[56:59], v7 offset:61440
    s_add_u32 m0, s62, 116736
    s_nop 0
    buffer_load_dwordx4 v3, s[8:11], s23 offen lds
    v_mfma_f32_16x16x32_bf16 v[20:23], v[212:215], v[68:71], v[20:23]
    s_add_u32 m0, s62, 117760
    s_nop 0
    buffer_load_dwordx4 v4, s[8:11], s23 offen lds
    v_mfma_f32_16x16x32_bf16 v[24:27], v[212:215], v[72:75], v[24:27]
    s_waitcnt vmcnt(28) lgkmcnt(4)
    v_mfma_f32_16x16x32_bf16 v[12:15], v[92:95], v[76:79], v[12:15]
    ds_read_b128 v[60:63], v8 offset:49152
    ds_read_b128 v[64:67], v8 offset:53248
    v_mfma_f32_16x16x32_bf16 v[16:19], v[92:95], v[80:83], v[16:19]
    ds_read_b128 v[68:71], v8 offset:57344
    ds_read_b128 v[72:75], v8 offset:61440
    buffer_load_dwordx4 v[196:199], v221, s[16:19], s21 offen offset:0 sc1
    v_mfma_f32_16x16x32_bf16 v[20:23], v[92:95], v[84:87], v[20:23]
    buffer_load_dwordx4 v[204:207], v222, s[16:19], s21 offen offset:0 sc1
    v_mfma_f32_16x16x32_bf16 v[24:27], v[92:95], v[88:91], v[24:27]
    s_waitcnt vmcnt(25) lgkmcnt(4)
    v_mfma_f32_16x16x32_bf16 v[12:15], v[100:103], v[44:47], v[12:15]
    ds_read_b128 v[76:79], v9 offset:49152
    ds_read_b128 v[80:83], v9 offset:53248
    v_mfma_f32_16x16x32_bf16 v[16:19], v[100:103], v[48:51], v[16:19]
    ds_read_b128 v[84:87], v9 offset:57344
    ds_read_b128 v[88:91], v9 offset:61440
    buffer_load_dwordx4 v[212:215], v223, s[16:19], s21 offen offset:0 sc1
    v_mfma_f32_16x16x32_bf16 v[20:23], v[100:103], v[52:55], v[20:23]
    s_add_u32 s21, s69, 15
    s_and_b32 s21, s21, 15
    s_mul_i32 s21, s21, 28672
    s_add_u32 s21, s21, s63
    buffer_load_dwordx4 v[92:95], v220, s[16:19], s21 offen offset:0 sc1
    v_mfma_f32_16x16x32_bf16 v[24:27], v[100:103], v[56:59], v[24:27]
    s_waitcnt vmcnt(20) lgkmcnt(0)
    s_barrier
    v_mfma_f32_16x16x32_bf16 v[12:15], v[108:111], v[60:63], v[12:15]
    ds_read_b128 v[44:47], v6 offset:0
    ds_read_b128 v[48:51], v6 offset:4096
    v_mfma_f32_16x16x32_bf16 v[16:19], v[108:111], v[64:67], v[16:19]
    ds_read_b128 v[52:55], v6 offset:8192
    ds_read_b128 v[56:59], v6 offset:12288
    s_add_u32 s22, s69, 15
    s_and_b32 s22, s22, 15
    s_lshl_b32 s23, s22, 8
    s_add_u32 s23, s23, s61
    s_add_u32 m0, s62, 131072
    s_nop 0
    buffer_load_dwordx4 v1, s[8:11], s23 offen lds
    v_mfma_f32_16x16x32_bf16 v[20:23], v[108:111], v[68:71], v[20:23]
    s_add_u32 m0, s62, 132096
    s_nop 0
    buffer_load_dwordx4 v2, s[8:11], s23 offen lds
    v_mfma_f32_16x16x32_bf16 v[24:27], v[108:111], v[72:75], v[24:27]
    s_waitcnt vmcnt(27) lgkmcnt(4)
    v_mfma_f32_16x16x32_bf16 v[12:15], v[156:159], v[76:79], v[12:15]
    ds_read_b128 v[60:63], v7 offset:0
    ds_read_b128 v[64:67], v7 offset:4096
    v_mfma_f32_16x16x32_bf16 v[16:19], v[156:159], v[80:83], v[16:19]
    ds_read_b128 v[68:71], v7 offset:8192
    ds_read_b128 v[72:75], v7 offset:12288
    s_add_u32 m0, s62, 133120
    s_nop 0
    buffer_load_dwordx4 v3, s[8:11], s23 offen lds
    v_mfma_f32_16x16x32_bf16 v[20:23], v[156:159], v[84:87], v[20:23]
    s_add_u32 m0, s62, 134144
    s_nop 0
    buffer_load_dwordx4 v4, s[8:11], s23 offen lds
    v_mfma_f32_16x16x32_bf16 v[24:27], v[156:159], v[88:91], v[24:27]
    s_waitcnt vmcnt(28) lgkmcnt(4)
    v_mfma_f32_16x16x32_bf16 v[12:15], v[164:167], v[44:47], v[12:15]
    ds_read_b128 v[76:79], v8 offset:0
    ds_read_b128 v[80:83], v8 offset:4096
    v_mfma_f32_16x16x32_bf16 v[16:19], v[164:167], v[48:51], v[16:19]
    ds_read_b128 v[84:87], v8 offset:8192
    ds_read_b128 v[88:91], v8 offset:12288
    buffer_load_dwordx4 v[100:103], v221, s[16:19], s21 offen offset:0 sc1
    v_mfma_f32_16x16x32_bf16 v[20:23], v[164:167], v[52:55], v[20:23]
    buffer_load_dwordx4 v[108:111], v222, s[16:19], s21 offen offset:0 sc1
    v_mfma_f32_16x16x32_bf16 v[24:27], v[164:167], v[56:59], v[24:27]
    s_waitcnt vmcnt(25) lgkmcnt(4)
    v_mfma_f32_16x16x32_bf16 v[12:15], v[116:119], v[60:63], v[12:15]
    ds_read_b128 v[44:47], v9 offset:0
    ds_read_b128 v[48:51], v9 offset:4096
    v_mfma_f32_16x16x32_bf16 v[16:19], v[116:119], v[64:67], v[16:19]
    ds_read_b128 v[52:55], v9 offset:8192
    ds_read_b128 v[56:59], v9 offset:12288
    buffer_load_dwordx4 v[156:159], v223, s[16:19], s21 offen offset:0 sc1
    v_mfma_f32_16x16x32_bf16 v[20:23], v[116:119], v[68:71], v[20:23]
    v_mfma_f32_16x16x32_bf16 v[24:27], v[116:119], v[72:75], v[24:27]
    s_waitcnt vmcnt(19) lgkmcnt(0)
    s_barrier
    v_mfma_f32_16x16x32_bf16 v[12:15], v[124:127], v[76:79], v[12:15]
    ds_read_b128 v[60:63], v6 offset:16384
    ds_read_b128 v[64:67], v6 offset:20480
    v_mfma_f32_16x16x32_bf16 v[16:19], v[124:127], v[80:83], v[16:19]
    ds_read_b128 v[68:71], v6 offset:24576
    ds_read_b128 v[72:75], v6 offset:28672
    v_mfma_f32_16x16x32_bf16 v[20:23], v[124:127], v[84:87], v[20:23]
    v_mfma_f32_16x16x32_bf16 v[24:27], v[124:127], v[88:91], v[24:27]
    s_waitcnt vmcnt(24) lgkmcnt(4)
    v_mfma_f32_16x16x32_bf16 v[12:15], v[132:135], v[44:47], v[12:15]
    ds_read_b128 v[76:79], v7 offset:16384
    ds_read_b128 v[80:83], v7 offset:20480
    v_mfma_f32_16x16x32_bf16 v[16:19], v[132:135], v[48:51], v[16:19]
    ds_read_b128 v[84:87], v7 offset:24576
    ds_read_b128 v[88:91], v7 offset:28672
    v_mfma_f32_16x16x32_bf16 v[20:23], v[132:135], v[52:55], v[20:23]
    v_mfma_f32_16x16x32_bf16 v[24:27], v[132:135], v[56:59], v[24:27]
    s_waitcnt vmcnt(23) lgkmcnt(4)
    v_mfma_f32_16x16x32_bf16 v[12:15], v[140:143], v[60:63], v[12:15]
    ds_read_b128 v[44:47], v8 offset:16384
    ds_read_b128 v[48:51], v8 offset:20480
    v_mfma_f32_16x16x32_bf16 v[16:19], v[140:143], v[64:67], v[16:19]
    ds_read_b128 v[52:55], v8 offset:24576
    ds_read_b128 v[56:59], v8 offset:28672
    v_mfma_f32_16x16x32_bf16 v[20:23], v[140:143], v[68:71], v[20:23]
    v_mfma_f32_16x16x32_bf16 v[24:27], v[140:143], v[72:75], v[24:27]
    s_waitcnt vmcnt(18) lgkmcnt(4)
    v_mfma_f32_16x16x32_bf16 v[12:15], v[172:175], v[76:79], v[12:15]
    ds_read_b128 v[60:63], v9 offset:16384
    ds_read_b128 v[64:67], v9 offset:20480
    v_mfma_f32_16x16x32_bf16 v[16:19], v[172:175], v[80:83], v[16:19]
    ds_read_b128 v[68:71], v9 offset:24576
    ds_read_b128 v[72:75], v9 offset:28672
    v_mfma_f32_16x16x32_bf16 v[20:23], v[172:175], v[84:87], v[20:23]
    v_mfma_f32_16x16x32_bf16 v[24:27], v[172:175], v[88:91], v[24:27]
    s_waitcnt vmcnt(11) lgkmcnt(0)
    s_barrier
    v_mfma_f32_16x16x32_bf16 v[12:15], v[180:183], v[44:47], v[12:15]
    ds_read_b128 v[76:79], v6 offset:32768
    ds_read_b128 v[80:83], v6 offset:36864
    v_mfma_f32_16x16x32_bf16 v[16:19], v[180:183], v[48:51], v[16:19]
    ds_read_b128 v[84:87], v6 offset:40960
    ds_read_b128 v[88:91], v6 offset:45056
    v_mfma_f32_16x16x32_bf16 v[20:23], v[180:183], v[52:55], v[20:23]
    v_mfma_f32_16x16x32_bf16 v[24:27], v[180:183], v[56:59], v[24:27]
    s_waitcnt vmcnt(16) lgkmcnt(4)
    v_mfma_f32_16x16x32_bf16 v[12:15], v[148:151], v[60:63], v[12:15]
    ds_read_b128 v[44:47], v7 offset:32768
    ds_read_b128 v[48:51], v7 offset:36864
    v_mfma_f32_16x16x32_bf16 v[16:19], v[148:151], v[64:67], v[16:19]
    ds_read_b128 v[52:55], v7 offset:40960
    ds_read_b128 v[56:59], v7 offset:45056
    v_mfma_f32_16x16x32_bf16 v[20:23], v[148:151], v[68:71], v[20:23]
    v_mfma_f32_16x16x32_bf16 v[24:27], v[148:151], v[72:75], v[24:27]
    s_waitcnt vmcnt(15) lgkmcnt(4)
    v_mfma_f32_16x16x32_bf16 v[12:15], v[188:191], v[76:79], v[12:15]
    ds_read_b128 v[60:63], v8 offset:32768
    ds_read_b128 v[64:67], v8 offset:36864
    v_mfma_f32_16x16x32_bf16 v[16:19], v[188:191], v[80:83], v[16:19]
    ds_read_b128 v[68:71], v8 offset:40960
    ds_read_b128 v[72:75], v8 offset:45056
    v_mfma_f32_16x16x32_bf16 v[20:23], v[188:191], v[84:87], v[20:23]
    v_mfma_f32_16x16x32_bf16 v[24:27], v[188:191], v[88:91], v[24:27]
    s_waitcnt vmcnt(10) lgkmcnt(4)
    v_mfma_f32_16x16x32_bf16 v[12:15], v[196:199], v[44:47], v[12:15]
    ds_read_b128 v[76:79], v9 offset:32768
    ds_read_b128 v[80:83], v9 offset:36864
    ds_read_b64 v[224:225], v10 offset:0
    v_mfma_f32_16x16x32_bf16 v[16:19], v[196:199], v[48:51], v[16:19]
    ds_read_b128 v[84:87], v9 offset:40960
    ds_read_b128 v[88:91], v9 offset:45056
    ds_read_b64 v[228:229], v10 offset:3584
    v_mfma_f32_16x16x32_bf16 v[20:23], v[196:199], v[52:55], v[20:23]
    ds_read_b64 v[232:233], v10 offset:7168
    v_mfma_f32_16x16x32_bf16 v[24:27], v[196:199], v[56:59], v[24:27]
    ds_read_b64 v[236:237], v10 offset:10752
    s_waitcnt vmcnt(3) lgkmcnt(0)
    s_barrier
    v_mfma_f32_16x16x32_bf16 v[12:15], v[204:207], v[60:63], v[12:15]
    ds_read_b128 v[44:47], v6 offset:49152
    ds_read_b128 v[48:51], v6 offset:53248
    v_mfma_f32_16x16x32_bf16 v[16:19], v[204:207], v[64:67], v[16:19]
    ds_read_b128 v[52:55], v6 offset:57344
    ds_read_b128 v[56:59], v6 offset:61440
    v_mfma_f32_16x16x32_bf16 v[20:23], v[204:207], v[68:71], v[20:23]
    v_mfma_f32_16x16x32_bf16 v[24:27], v[204:207], v[72:75], v[24:27]
    s_waitcnt vmcnt(8) lgkmcnt(0)
    v_mfma_f32_16x16x32_bf16 v[12:15], v[212:215], v[76:79], v[12:15]
    ds_read_b128 v[60:63], v7 offset:49152
    ds_read_b128 v[64:67], v7 offset:53248
    v_lshlrev_b32 v164, 16, v224
    v_and_b32 v165, 0xffff0000, v224
    v_lshlrev_b32 v166, 16, v225
    v_and_b32 v167, 0xffff0000, v225
    v_mfma_f32_16x16x32_bf16 v[16:19], v[212:215], v[80:83], v[16:19]
    ds_read_b128 v[68:71], v7 offset:57344
    ds_read_b128 v[72:75], v7 offset:61440
    v_lshlrev_b32 v168, 16, v228
    v_and_b32 v169, 0xffff0000, v228
    v_lshlrev_b32 v170, 16, v229
    v_mfma_f32_16x16x32_bf16 v[20:23], v[212:215], v[84:87], v[20:23]
    v_and_b32 v171, 0xffff0000, v229
    v_lshlrev_b32 v116, 16, v232
    v_and_b32 v117, 0xffff0000, v232
    v_mfma_f32_16x16x32_bf16 v[24:27], v[212:215], v[88:91], v[24:27]
    v_lshlrev_b32 v118, 16, v233
    v_and_b32 v119, 0xffff0000, v233
    v_lshlrev_b32 v120, 16, v236
    s_waitcnt vmcnt(7) lgkmcnt(4)
    v_mfma_f32_16x16x32_bf16 v[12:15], v[92:95], v[44:47], v[12:15]
    ds_read_b128 v[76:79], v8 offset:49152
    ds_read_b128 v[80:83], v8 offset:53248
    v_and_b32 v121, 0xffff0000, v236
    v_lshlrev_b32 v122, 16, v237
    v_and_b32 v123, 0xffff0000, v237
    v_mul_f32 v140, v164, v250
    v_mfma_f32_16x16x32_bf16 v[16:19], v[92:95], v[48:51], v[16:19]
    ds_read_b128 v[84:87], v8 offset:57344
    ds_read_b128 v[88:91], v8 offset:61440
    v_mul_f32 v141, v165, v250
    v_mul_f32 v142, v166, v250
    v_mul_f32 v143, v167, v250
    v_mfma_f32_16x16x32_bf16 v[20:23], v[92:95], v[52:55], v[20:23]
    v_mul_f32 v144, v168, v251
    v_mul_f32 v145, v169, v251
    v_mul_f32 v146, v170, v251
    v_mfma_f32_16x16x32_bf16 v[24:27], v[92:95], v[56:59], v[24:27]
    v_mul_f32 v147, v171, v251
    v_mul_f32 v172, v116, v252
    v_mul_f32 v173, v117, v252
    s_waitcnt vmcnt(2) lgkmcnt(4)
    v_mfma_f32_16x16x32_bf16 v[12:15], v[100:103], v[60:63], v[12:15]
    ds_read_b128 v[44:47], v9 offset:49152
    ds_read_b128 v[48:51], v9 offset:53248
    v_mul_f32 v174, v118, v252
    v_mul_f32 v175, v119, v252
    v_mfma_f32_16x16x32_bf16 v[16:19], v[100:103], v[64:67], v[16:19]
    ds_read_b128 v[52:55], v9 offset:57344
    ds_read_b128 v[56:59], v9 offset:61440
    v_mul_f32 v176, v120, v253
    v_mfma_f32_16x16x32_bf16 v[20:23], v[100:103], v[68:71], v[20:23]
    v_mul_f32 v177, v121, v253
    v_mul_f32 v178, v122, v253
    v_mfma_f32_16x16x32_bf16 v[24:27], v[100:103], v[72:75], v[24:27]
    v_mul_f32 v179, v123, v253
    s_waitcnt vmcnt(1) lgkmcnt(4)
    v_mfma_f32_16x16x32_bf16 v[12:15], v[108:111], v[76:79], v[12:15]
    v_mfma_f32_16x16x32_bf16 v[16:19], v[108:111], v[80:83], v[16:19]
    v_mfma_f32_16x16x32_bf16 v[20:23], v[108:111], v[84:87], v[20:23]
    v_mfma_f32_16x16x32_bf16 v[24:27], v[108:111], v[88:91], v[24:27]
    s_waitcnt vmcnt(0) lgkmcnt(0)
    v_mfma_f32_16x16x32_bf16 v[12:15], v[156:159], v[44:47], v[12:15]
    v_mfma_f32_16x16x32_bf16 v[16:19], v[156:159], v[48:51], v[16:19]
    v_mfma_f32_16x16x32_bf16 v[20:23], v[156:159], v[52:55], v[20:23]
    v_mfma_f32_16x16x32_bf16 v[24:27], v[156:159], v[56:59], v[24:27]
    s_lshl_b32 s20, s4, 3
    s_add_u32 s20, s20, s5
    s_lshl_b32 s20, s20, 11
    s_add_u32 s20, s20, 10485760
    s_nop 0
    v_pk_fma_f32 v[12:13], v[12:13], v[164:165], v[140:141]
    v_pk_fma_f32 v[14:15], v[14:15], v[166:167], v[142:143]
    v_cvt_pk_bf16_f32 v44, v12, v13
    v_cvt_pk_bf16_f32 v45, v14, v15
    buffer_store_dwordx2 v[44:45], v11, s[16:19], s20 offen offset:0 sc1
    v_pk_fma_f32 v[16:17], v[16:17], v[168:169], v[144:145]
    v_pk_fma_f32 v[18:19], v[18:19], v[170:171], v[146:147]
    v_cvt_pk_bf16_f32 v46, v16, v17
    v_cvt_pk_bf16_f32 v47, v18, v19
    buffer_store_dwordx2 v[46:47], v11, s[16:19], s20 offen offset:512 sc1
    v_pk_fma_f32 v[20:21], v[20:21], v[116:117], v[172:173]
    v_pk_fma_f32 v[22:23], v[22:23], v[118:119], v[174:175]
    v_cvt_pk_bf16_f32 v48, v20, v21
    v_cvt_pk_bf16_f32 v49, v22, v23
    buffer_store_dwordx2 v[48:49], v11, s[16:19], s20 offen offset:1024 sc1
    v_pk_fma_f32 v[24:25], v[24:25], v[120:121], v[176:177]
    v_pk_fma_f32 v[26:27], v[26:27], v[122:123], v[178:179]
    v_cvt_pk_bf16_f32 v50, v24, v25
    v_cvt_pk_bf16_f32 v51, v26, v27
    buffer_store_dwordx2 v[50:51], v11, s[16:19], s20 offen offset:1536 sc1
L_g2x:
    s_setprio 0
    s_barrier
    s_lshl_b32 s20, s4, 3
    s_add_u32 s20, s20, s5
    s_lshl_b32 s20, s20, 2
    s_add_u32 s20, s20, s3
    s_lshl_b32 s20, s20, 7
    s_add_u32 s20, s20, 524288
    s_waitcnt vmcnt(0)
    v_mov_b32 v200, s6
    v_mov_b32 v201, s7
    v_mov_b32 v202, 0
    s_mov_b64 exec, 1
    buffer_store_dwordx2 v[200:201], v202, s[16:19], s20 offen sc1
    s_mov_b64 exec, -1
    s_branch L_x2
L_ssm:
    s_sub_u32 s78, s3, 4
    s_lshr_b32 s76, s78, 1
    s_and_b32 s77, s78, 1
    s_mov_b32 s74, 0x3fb8aa3b
    s_mov_b32 s75, 0x32a57060
    s_lshl_b32 s22, s76, 4
    s_lshr_b32 s23, s57, s22
    s_lshl_b32 s23, s23, 16
    s_lshr_b32 s58, s58, s22
    s_lshl_b32 s58, s58, 16
    v_mov_b32 v68, s23
    v_lshlrev_b32 v250, 16, v250
    v_lshlrev_b32 v251, 16, v251
    v_lshlrev_b32 v252, 16, v252
    v_lshlrev_b32 v253, 16, v253
    v_mul_f32 v64, s74, v68
    v_fma_f32 v65, v68, s74, -v64
    v_fma_f32 v65, v68, s75, v65
    v_rndne_f32 v66, v64
    v_sub_f32 v64, v64, v66
    v_add_f32 v64, v64, v65
    v_exp_f32 v64, v64
    v_cvt_i32_f32 v66, v66
    v_ldexp_f32 v64, v64, v66
    v_cvt_pk_bf16_f32 v64, v64, v64
    v_lshlrev_b32 v68, 16, v64
    v_mul_f32 v64, s74, v250
    v_fma_f32 v65, v250, s74, -v64
    v_fma_f32 v65, v250, s75, v65
    v_rndne_f32 v66, v64
    v_sub_f32 v64, v64, v66
    v_add_f32 v64, v64, v65
    v_exp_f32 v64, v64
    v_cvt_i32_f32 v66, v66
    v_ldexp_f32 v64, v64, v66
    v_cvt_pk_bf16_f32 v64, v64, v64
    v_lshlrev_b32 v250, 16, v64
    v_mul_f32 v60, v250, v68
    v_mul_f32 v61, v251, v68
    v_mul_f32 v60, 0xbfb8aa3b, v60
    v_mul_f32 v61, 0.15915494, v61
    v_max_f32 v64, |v252|, |v253|
    s_nop 1
    v_max_f32_dpp v64, v64, v64 row_ror:8 row_mask:0xf bank_mask:0xf
    s_nop 1
    v_max_f32_dpp v64, v64, v64 row_ror:4 row_mask:0xf bank_mask:0xf
    s_nop 1
    v_max_f32_dpp v64, v64, v64 row_ror:2 row_mask:0xf bank_mask:0xf
    s_nop 1
    v_max_f32_dpp v64, v64, v64 row_ror:1 row_mask:0xf bank_mask:0xf
    v_add_f32 v68, v68, v68
    v_readlane_b32 s22, v64, 0
    v_readlane_b32 s23, v64, 16
    v_readlane_b32 s72, v64, 32
    v_readlane_b32 s73, v64, 48
    s_max_u32 s22, s22, s23
    s_max_u32 s72, s72, s73
    s_max_u32 s22, s22, s72
    s_lshr_b32 s22, s22, 23
    s_min_u32 s22, s22, 253
    s_sub_u32 s23, 254, s22
    s_lshl_b32 s23, s23, 23
    s_lshl_b32 s22, s22, 23
    v_mul_f32 v62, s23, v252
    v_mul_f32 v63, s23, v253
    v_mul_f32 v68, s22, v68
    s_nop 0
    v_readfirstlane_b32 s79, v68
    v_mul_f32 v64, 0x3f800000, v60
    v_mul_f32 v65, 0x3f800000, v61
    v_exp_f32 v64, v64
    v_fract_f32 v65, v65
    v_cos_f32 v66, v65
    v_sin_f32 v67, v65
    v_mul_f32 v68, v64, v66
    v_mul_f32 v69, v64, v67
    v_mul_f32 v64, 0x43800000, v60
    v_mul_f32 v65, 0x43800000, v61
    v_exp_f32 v64, v64
    v_fract_f32 v65, v65
    v_cos_f32 v66, v65
    v_sin_f32 v67, v65
    v_mul_f32 v74, v64, v66
    v_mul_f32 v75, v64, v67
    v_mul_f32 v64, 0x44800000, v60
    v_mul_f32 v65, 0x44800000, v61
    v_exp_f32 v64, v64
    v_fract_f32 v65, v65
    v_cos_f32 v66, v65
    v_sin_f32 v67, v65
    v_mul_f32 v78, v64, v66
    v_mul_f32 v79, v64, v67
    v_mul_f32 v64, v69, v69
    v_add_f32 v65, v68, v68
    v_fma_f32 v70, v68, v68, -v64
    v_mul_f32 v71, v65, v69
    v_mul_f32 v64, v75, v75
    v_add_f32 v65, v74, v74
    v_fma_f32 v76, v74, v74, -v64
    v_mul_f32 v77, v65, v75
    v_mul_f32 v64, v71, v71
    v_add_f32 v65, v70, v70
    v_fma_f32 v72, v70, v70, -v64
    v_mul_f32 v73, v65, v71
    v_cvt_pk_f16_f32 v100, v62, v63
    v_mul_f32 v64, v63, v69
    v_mul_f32 v65, v63, v68
    v_fma_f32 v80, v62, v68, -v64
    v_fma_f32 v81, v62, v69, v65
    v_cvt_pk_f16_f32 v101, v80, v81
    v_mul_f32 v64, v63, v71
    v_mul_f32 v65, v63, v70
    v_fma_f32 v82, v62, v70, -v64
    v_fma_f32 v83, v62, v71, v65
    v_cvt_pk_f16_f32 v102, v82, v83
    v_mul_f32 v64, v81, v71
    v_mul_f32 v65, v81, v70
    v_fma_f32 v84, v80, v70, -v64
    v_fma_f32 v85, v80, v71, v65
    v_cvt_pk_f16_f32 v103, v84, v85
    v_mul_f32 v64, v63, v73
    v_mul_f32 v65, v63, v72
    v_fma_f32 v86, v62, v72, -v64
    v_fma_f32 v87, v62, v73, v65
    v_cvt_pk_f16_f32 v104, v86, v87
    v_mul_f32 v64, v81, v73
    v_mul_f32 v65, v81, v72
    v_fma_f32 v86, v80, v72, -v64
    v_fma_f32 v87, v80, v73, v65
    v_cvt_pk_f16_f32 v105, v86, v87
    v_mul_f32 v64, v83, v73
    v_mul_f32 v65, v83, v72
    v_fma_f32 v86, v82, v72, -v64
    v_fma_f32 v87, v82, v73, v65
    v_cvt_pk_f16_f32 v106, v86, v87
    v_mul_f32 v64, v85, v73
    v_mul_f32 v65, v85, v72
    v_fma_f32 v86, v84, v72, -v64
    v_fma_f32 v87, v84, v73, v65
    v_cvt_pk_f16_f32 v107, v86, v87
    v_mul_f32 v64, v63, v75
    v_mul_f32 v65, v63, v74
    v_fma_f32 v88, v62, v74, -v64
    v_fma_f32 v89, v62, v75, v65
    v_cvt_pk_f16_f32 v108, v88, v89
    v_mul_f32 v64, v89, v71
    v_mul_f32 v65, v89, v70
    v_fma_f32 v90, v88, v70, -v64
    v_fma_f32 v91, v88, v71, v65
    v_cvt_pk_f16_f32 v109, v90, v91
    v_mul_f32 v64, v89, v73
    v_mul_f32 v65, v89, v72
    v_fma_f32 v86, v88, v72, -v64
    v_fma_f32 v87, v88, v73, v65
    v_cvt_pk_f16_f32 v110, v86, v87
    v_mul_f32 v64, v91, v73
    v_mul_f32 v65, v91, v72
    v_fma_f32 v86, v90, v72, -v64
    v_fma_f32 v87, v90, v73, v65
    v_cvt_pk_f16_f32 v111, v86, v87
    v_mul_f32 v64, v63, v77
    v_mul_f32 v65, v63, v76
    v_fma_f32 v92, v62, v76, -v64
    v_fma_f32 v93, v62, v77, v65
    v_cvt_pk_f16_f32 v112, v92, v93
    v_mul_f32 v64, v93, v73
    v_mul_f32 v65, v93, v72
    v_fma_f32 v94, v92, v72, -v64
    v_fma_f32 v95, v92, v73, v65
    v_cvt_pk_f16_f32 v113, v94, v95
    v_mul_f32 v64, v93, v75
    v_mul_f32 v65, v93, v74
    v_fma_f32 v86, v92, v74, -v64
    v_fma_f32 v87, v92, v75, v65
    v_cvt_pk_f16_f32 v114, v86, v87
    v_mul_f32 v64, v95, v75
    v_mul_f32 v65, v95, v74
    v_fma_f32 v86, v94, v74, -v64
    v_fma_f32 v87, v94, v75, v65
    v_cvt_pk_f16_f32 v115, v86, v87
    v_mul_f32 v64, v63, v79
    v_mul_f32 v65, v63, v78
    v_fma_f32 v96, v62, v78, -v64
    v_fma_f32 v97, v62, v79, v65
    v_cvt_pk_f16_f32 v116, v96, v97
    v_mul_f32 v64, v97, v75
    v_mul_f32 v65, v97, v74
    v_fma_f32 v98, v96, v74, -v64
    v_fma_f32 v99, v96, v75, v65
    v_cvt_pk_f16_f32 v117, v98, v99
    v_mul_f32 v64, v97, v77
    v_mul_f32 v65, v97, v76
    v_fma_f32 v86, v96, v76, -v64
    v_fma_f32 v87, v96, v77, v65
    v_cvt_pk_f16_f32 v118, v86, v87
    v_mul_f32 v64, v99, v77
    v_mul_f32 v65, v99, v76
    v_fma_f32 v86, v98, v76, -v64
    v_fma_f32 v87, v98, v77, v65
    v_cvt_pk_f16_f32 v119, v86, v87
    v_mul_f32 v64, v97, v79
    v_mul_f32 v65, v97, v78
    v_fma_f32 v86, v96, v78, -v64
    v_fma_f32 v87, v96, v79, v65
    v_cvt_pk_f16_f32 v120, v86, v87
    v_mov_b32 v121, 0x3c00
    v_mul_f32 v64, 0x41000000, v60
    v_mul_f32 v65, 0x41000000, v61
    v_exp_f32 v64, v64
    v_fract_f32 v65, v65
    v_cos_f32 v66, v65
    v_sin_f32 v67, v65
    v_mul_f32 v68, v64, v66
    v_mul_f32 v69, -v64, v67
    v_mul_f32 v64, 0x42800000, v60
    v_mul_f32 v65, 0x42800000, v61
    v_exp_f32 v64, v64
    v_fract_f32 v65, v65
    v_cos_f32 v66, v65
    v_sin_f32 v67, v65
    v_mul_f32 v82, v64, v66
    v_mul_f32 v83, -v64, v67
    v_cvt_pk_f16_f32 v122, v68, v69
    v_cvt_pk_f16_f32 v129, v82, v83
    v_mul_f32 v64, v69, v69
    v_add_f32 v65, v68, v68
    v_fma_f32 v70, v68, v68, -v64
    v_mul_f32 v71, v65, v69
    v_cvt_pk_f16_f32 v123, v70, v71
    v_mul_f32 v64, v83, v83
    v_add_f32 v65, v82, v82
    v_fma_f32 v98, v82, v82, -v64
    v_mul_f32 v99, v65, v83
    v_cvt_pk_f16_f32 v137, v98, v99
    v_mul_f32 v64, v71, v69
    v_mul_f32 v65, v71, v68
    v_fma_f32 v72, v70, v68, -v64
    v_fma_f32 v73, v70, v69, v65
    v_cvt_pk_f16_f32 v124, v72, v73
    v_mul_f32 v64, v71, v71
    v_add_f32 v65, v70, v70
    v_fma_f32 v74, v70, v70, -v64
    v_mul_f32 v75, v65, v71
    v_cvt_pk_f16_f32 v125, v74, v75
    v_mul_f32 v64, v75, v69
    v_mul_f32 v65, v75, v68
    v_fma_f32 v76, v74, v68, -v64
    v_fma_f32 v77, v74, v69, v65
    v_cvt_pk_f16_f32 v126, v76, v77
    v_mul_f32 v64, v75, v71
    v_mul_f32 v65, v75, v70
    v_fma_f32 v78, v74, v70, -v64
    v_fma_f32 v79, v74, v71, v65
    v_cvt_pk_f16_f32 v127, v78, v79
    v_mul_f32 v64, v75, v73
    v_mul_f32 v65, v75, v72
    v_fma_f32 v80, v74, v72, -v64
    v_fma_f32 v81, v74, v73, v65
    v_cvt_pk_f16_f32 v128, v80, v81
    v_mul_f32 v64, v83, v69
    v_mul_f32 v65, v83, v68
    v_fma_f32 v84, v82, v68, -v64
    v_fma_f32 v85, v82, v69, v65
    v_cvt_pk_f16_f32 v130, v84, v85
    v_mul_f32 v64, v83, v71
    v_mul_f32 v65, v83, v70
    v_fma_f32 v86, v82, v70, -v64
    v_fma_f32 v87, v82, v71, v65
    v_cvt_pk_f16_f32 v131, v86, v87
    v_mul_f32 v64, v83, v73
    v_mul_f32 v65, v83, v72
    v_fma_f32 v88, v82, v72, -v64
    v_fma_f32 v89, v82, v73, v65
    v_cvt_pk_f16_f32 v132, v88, v89
    v_mul_f32 v64, v83, v75
    v_mul_f32 v65, v83, v74
    v_fma_f32 v90, v82, v74, -v64
    v_fma_f32 v91, v82, v75, v65
    v_cvt_pk_f16_f32 v133, v90, v91
    v_mul_f32 v64, v83, v77
    v_mul_f32 v65, v83, v76
    v_fma_f32 v92, v82, v76, -v64
    v_fma_f32 v93, v82, v77, v65
    v_cvt_pk_f16_f32 v134, v92, v93
    v_mul_f32 v64, v83, v79
    v_mul_f32 v65, v83, v78
    v_fma_f32 v94, v82, v78, -v64
    v_fma_f32 v95, v82, v79, v65
    v_cvt_pk_f16_f32 v135, v94, v95
    v_mul_f32 v64, v83, v81
    v_mul_f32 v65, v83, v80
    v_fma_f32 v96, v82, v80, -v64
    v_fma_f32 v97, v82, v81, v65
    v_cvt_pk_f16_f32 v136, v96, v97
    v_mul_f32 v64, v99, v69
    v_mul_f32 v65, v99, v68
    v_fma_f32 v62, v98, v68, -v64
    v_fma_f32 v63, v98, v69, v65
    v_cvt_pk_f16_f32 v138, v62, v63
    v_mul_f32 v64, v99, v71
    v_mul_f32 v65, v99, v70
    v_fma_f32 v62, v98, v70, -v64
    v_fma_f32 v63, v98, v71, v65
    v_cvt_pk_f16_f32 v139, v62, v63
    v_mul_f32 v64, v99, v73
    v_mul_f32 v65, v99, v72
    v_fma_f32 v62, v98, v72, -v64
    v_fma_f32 v63, v98, v73, v65
    v_cvt_pk_f16_f32 v140, v62, v63
    v_mul_f32 v64, v99, v75
    v_mul_f32 v65, v99, v74
    v_fma_f32 v62, v98, v74, -v64
    v_fma_f32 v63, v98, v75, v65
    v_cvt_pk_f16_f32 v141, v62, v63
    v_mul_f32 v64, v99, v77
    v_mul_f32 v65, v99, v76
    v_fma_f32 v62, v98, v76, -v64
    v_fma_f32 v63, v98, v77, v65
    v_cvt_pk_f16_f32 v142, v62, v63
    v_mul_f32 v64, v99, v79
    v_mul_f32 v65, v99, v78
    v_fma_f32 v62, v98, v78, -v64
    v_fma_f32 v63, v98, v79, v65
    v_cvt_pk_f16_f32 v143, v62, v63
    v_mul_f32 v64, v99, v81
    v_mul_f32 v65, v99, v80
    v_fma_f32 v62, v98, v80, -v64
    v_fma_f32 v63, v98, v81, v65
    v_cvt_pk_f16_f32 v144, v62, v63
    v_mul_f32 v64, v99, v83
    v_mul_f32 v65, v99, v82
    v_fma_f32 v62, v98, v82, -v64
    v_fma_f32 v63, v98, v83, v65
    v_cvt_pk_f16_f32 v145, v62, v63
    v_mul_f32 v64, v99, v85
    v_mul_f32 v65, v99, v84
    v_fma_f32 v62, v98, v84, -v64
    v_fma_f32 v63, v98, v85, v65
    v_cvt_pk_f16_f32 v146, v62, v63
    v_mul_f32 v64, v99, v87
    v_mul_f32 v65, v99, v86
    v_fma_f32 v62, v98, v86, -v64
    v_fma_f32 v63, v98, v87, v65
    v_cvt_pk_f16_f32 v147, v62, v63
    v_mul_f32 v64, v99, v89
    v_mul_f32 v65, v99, v88
    v_fma_f32 v62, v98, v88, -v64
    v_fma_f32 v63, v98, v89, v65
    v_cvt_pk_f16_f32 v148, v62, v63
    v_mul_f32 v64, v99, v91
    v_mul_f32 v65, v99, v90
    v_fma_f32 v62, v98, v90, -v64
    v_fma_f32 v63, v98, v91, v65
    v_cvt_pk_f16_f32 v149, v62, v63
    v_mul_f32 v64, v99, v93
    v_mul_f32 v65, v99, v92
    v_fma_f32 v62, v98, v92, -v64
    v_fma_f32 v63, v98, v93, v65
    v_cvt_pk_f16_f32 v150, v62, v63
    v_mul_f32 v64, v99, v95
    v_mul_f32 v65, v99, v94
    v_fma_f32 v62, v98, v94, -v64
    v_fma_f32 v63, v98, v95, v65
    v_cvt_pk_f16_f32 v151, v62, v63
    v_mul_f32 v64, v99, v97
    v_mul_f32 v65, v99, v96
    v_fma_f32 v62, v98, v96, -v64
    v_fma_f32 v63, v98, v97, v65
    v_cvt_pk_f16_f32 v152, v62, v63
    s_mul_i32 s20, s78, 14416
    v_lshl_add_u32 v1, v0, 2, s20
    ds_write_b32 v1, v100 offset:0
    ds_write_b32 v1, v101 offset:272
    ds_write_b32 v1, v102 offset:544
    ds_write_b32 v1, v103 offset:816
    ds_write_b32 v1, v104 offset:1088
    ds_write_b32 v1, v105 offset:1360
    ds_write_b32 v1, v106 offset:1632
    ds_write_b32 v1, v107 offset:1904
    ds_write_b32 v1, v108 offset:2176
    ds_write_b32 v1, v109 offset:2448
    ds_write_b32 v1, v110 offset:2720
    ds_write_b32 v1, v111 offset:2992
    ds_write_b32 v1, v112 offset:3264
    ds_write_b32 v1, v113 offset:3536
    ds_write_b32 v1, v114 offset:3808
    ds_write_b32 v1, v115 offset:4080
    ds_write_b32 v1, v116 offset:4352
    ds_write_b32 v1, v117 offset:4624
    ds_write_b32 v1, v118 offset:4896
    ds_write_b32 v1, v119 offset:5168
    ds_write_b32 v1, v120 offset:5440
    ds_write_b32 v1, v121 offset:5712
    ds_write_b32 v1, v122 offset:5984
    ds_write_b32 v1, v123 offset:6256
    ds_write_b32 v1, v124 offset:6528
    ds_write_b32 v1, v125 offset:6800
    ds_write_b32 v1, v126 offset:7072
    ds_write_b32 v1, v127 offset:7344
    ds_write_b32 v1, v128 offset:7616
    ds_write_b32 v1, v129 offset:7888
    ds_write_b32 v1, v130 offset:8160
    ds_write_b32 v1, v131 offset:8432
    ds_write_b32 v1, v132 offset:8704
    ds_write_b32 v1, v133 offset:8976
    ds_write_b32 v1, v134 offset:9248
    ds_write_b32 v1, v135 offset:9520
    ds_write_b32 v1, v136 offset:9792
    ds_write_b32 v1, v137 offset:10064
    ds_write_b32 v1, v138 offset:10336
    ds_write_b32 v1, v139 offset:10608
    ds_write_b32 v1, v140 offset:10880
    ds_write_b32 v1, v141 offset:11152
    ds_write_b32 v1, v142 offset:11424
    ds_write_b32 v1, v143 offset:11696
    ds_write_b32 v1, v144 offset:11968
    ds_write_b32 v1, v145 offset:12240
    ds_write_b32 v1, v146 offset:12512
    ds_write_b32 v1, v147 offset:12784
    ds_write_b32 v1, v148 offset:13056
    ds_write_b32 v1, v149 offset:13328
    ds_write_b32 v1, v150 offset:13600
    ds_write_b32 v1, v151 offset:13872
    ds_write_b32 v1, v152 offset:14144
    s_waitcnt vmcnt(63) lgkmcnt(0)
    s_barrier
    s_mul_i32 s20, s78, 14416
    v_and_b32 v2, 31, v0
    v_mul_u32_u24 v2, 272, v2
    v_lshrrev_b32 v3, 5, v0
    v_lshl_add_u32 v2, v3, 4, v2
    v_add_u32 v2, s20, v2
    ds_read_b128 v[60:63], v2 offset:0
    ds_read_b128 v[64:67], v2 offset:5712
    ds_read_b128 v[68:71], v2 offset:32
    ds_read_b128 v[72:75], v2 offset:5744
    ds_read_b128 v[76:79], v2 offset:64
    ds_read_b128 v[80:83], v2 offset:5776
    ds_read_b128 v[84:87], v2 offset:96
    ds_read_b128 v[88:91], v2 offset:5808
    ds_read_b128 v[92:95], v2 offset:128
    ds_read_b128 v[96:99], v2 offset:5840
    ds_read_b128 v[100:103], v2 offset:160
    ds_read_b128 v[104:107], v2 offset:5872
    ds_read_b128 v[108:111], v2 offset:192
    ds_read_b128 v[112:115], v2 offset:5904
    ds_read_b128 v[116:119], v2 offset:224
    ds_read_b128 v[120:123], v2 offset:5936
    v_and_b32 v4, 31, v0
    s_mul_i32 s20, s78, 2608
    s_add_u32 s20, s20, 57680
    v_lshlrev_b32 v5, 5, v4
    v_lshl_add_u32 v5, v3, 4, v5
    v_add_u32 v5, s20, v5
    v_lshl_add_u32 v6, v4, 4, s20
    v_lshl_add_u32 v7, v4, 3, s20
    v_lshl_add_u32 v8, v4, 2, s20
    s_waitcnt lgkmcnt(14)
    v_mfma_f32_32x32x16_f16 v[124:139], v[60:63], v[64:67], 0
    s_waitcnt lgkmcnt(12)
    v_mfma_f32_32x32x16_f16 v[124:139], v[68:71], v[72:75], v[124:139]
    s_waitcnt lgkmcnt(10)
    v_mfma_f32_32x32x16_f16 v[124:139], v[76:79], v[80:83], v[124:139]
    s_waitcnt lgkmcnt(8)
    v_mfma_f32_32x32x16_f16 v[124:139], v[84:87], v[88:91], v[124:139]
    s_waitcnt lgkmcnt(6)
    v_mfma_f32_32x32x16_f16 v[124:139], v[92:95], v[96:99], v[124:139]
    s_waitcnt lgkmcnt(4)
    v_mfma_f32_32x32x16_f16 v[124:139], v[100:103], v[104:107], v[124:139]
    s_waitcnt lgkmcnt(2)
    v_mfma_f32_32x32x16_f16 v[124:139], v[108:111], v[112:115], v[124:139]
    s_waitcnt lgkmcnt(0)
    v_mfma_f32_32x32x16_f16 v[124:139], v[116:119], v[120:123], v[124:139]
    s_nop 11
    v_mul_f32 v124, s79, v124
    v_mul_f32 v125, s79, v125
    v_mul_f32 v126, s79, v126
    v_mul_f32 v127, s79, v127
    v_mul_f32 v128, s79, v128
    v_mul_f32 v129, s79, v129
    v_mul_f32 v130, s79, v130
    v_mul_f32 v131, s79, v131
    v_mul_f32 v132, s79, v132
    v_mul_f32 v133, s79, v133
    v_mul_f32 v134, s79, v134
    v_mul_f32 v135, s79, v135
    ds_write_b128 v5, v[124:127]
    s_mov_b32 exec_hi, 0
    ds_write_b128 v6, v[128:131] offset:1024
    ds_write_b32 v8, v132 offset:2048
    ds_write_b32 v8, v133 offset:2176
    ds_write_b32 v8, v134 offset:2304
    ds_write_b32 v8, v135 offset:2432
    s_mov_b32 exec_hi, -1
    s_mov_b32 exec_lo, 0
    ds_write_b64 v7, v[128:129] offset:1536
    ds_write_b64 v7, v[130:131] offset:1792
    s_mov_b32 exec_hi, 1
    ds_write_b32 v8, v132 offset:2560
    v_mov_b32 v9, 0
    v_add_u32 v8, -4, v8
    ds_write_b32 v8, v9
    s_mov_b64 exec, -1
    s_lshl_b32 s20, s5, 5
    s_add_u32 s20, s20, s4
    s_lshl_b32 s20, s20, 13
    s_lshl_b32 s21, s78, 11
    s_add_u32 s20, s20, s21
    s_add_u32 s20, s20, 5242880
    v_lshlrev_b32 v1, 4, v0
    buffer_load_dwordx4 v[12:15], v1, s[16:19], s20 offen offset:0 sc1
    buffer_load_dwordx4 v[16:19], v1, s[16:19], s20 offen offset:1024 sc1
    v_and_b32 v5, 15, v0
    s_lshl_b32 s20, s60, 4
    v_add_u32 v5, s20, v5
    v_lshlrev_b32 v5, 2, v5
    s_lshl_b32 s20, s4, 8
    s_add_u32 s20, s20, 16384
    buffer_load_dword v254, v5, s[16:19], s20 offen sc1
    s_waitcnt vmcnt(63) lgkmcnt(0)
    s_barrier
    s_mul_i32 s20, s76, 5216
    s_add_u32 s20, s20, 57680
    s_mul_i32 s21, s76, 8320
    s_add_u32 s21, s21, 4208
    v_lshlrev_b32 v2, 4, v0
    v_sub_u32 v2, s21, v2
    s_cmp_eq_u32 s77, 1
    s_cbranch_scc1 L_exb_25
    v_lshlrev_b32 v3, 5, v0
    v_lshl_add_u32 v4, v0, 4, 0
    v_add_u32 v4, 512, v4
    v_cmp_gt_u32 vcc, 32, v0
    s_nop 0
    s_mov_b64 s[72:73], vcc
    v_cndmask_b32 v3, v4, v3, vcc
    v_add_u32 v3, s20, v3
    v_add_u32 v4, -4, v3
    ds_read_b128 v[32:35], v3 offset:0
    ds_read_b128 v[36:39], v3 offset:16
    ds_read_b32 v40, v4 offset:0
    ds_read_b128 v[44:47], v3 offset:2608
    ds_read_b128 v[48:51], v3 offset:2624
    ds_read_b32 v52, v4 offset:2608
    v_cmp_gt_u32 s[22:23], 33, v0
    s_waitcnt lgkmcnt(0)
    v_add_f32 v32, v32, v44
    v_add_f32 v33, v33, v45
    v_add_f32 v34, v34, v46
    v_add_f32 v35, v35, v47
    v_add_f32 v36, v36, v48
    v_add_f32 v37, v37, v49
    v_add_f32 v38, v38, v50
    v_add_f32 v39, v39, v51
    v_add_f32 v40, v40, v52
    v_cndmask_b32 v45, v32, v33, s[72:73]
    v_cndmask_b32 v46, v33, v34, s[72:73]
    v_cndmask_b32 v47, v34, v35, s[72:73]
    v_cndmask_b32 v48, v34, v36, s[72:73]
    v_cndmask_b32 v49, v34, v37, s[72:73]
    v_cndmask_b32 v50, v35, v38, s[72:73]
    v_cndmask_b32 v51, v36, v39, s[72:73]
    v_cndmask_b32 v52, v32, v40, s[22:23]
    v_cvt_pk_bf16_f32 v56, v51, v50
    v_cvt_pk_bf16_f32 v57, v49, v48
    v_cvt_pk_bf16_f32 v58, v47, v46
    v_cvt_pk_bf16_f32 v59, v45, v32
    v_cvt_pk_bf16_f32 v60, v50, v49
    v_cvt_pk_bf16_f32 v61, v48, v47
    v_cvt_pk_bf16_f32 v62, v46, v45
    v_cvt_pk_bf16_f32 v63, v32, v52
    v_add_u32 v3, 0, v2
    ds_write_b128 v3, v[56:59]
    ds_write_b128 v3, v[60:63] offset:4160
    s_waitcnt vmcnt(63)
    s_barrier
    v_lshl_add_u32 v3, v0, 2, s20
    v_add_u32 v3, 2048, v3
    v_add_u32 v4, 2608, v3
    ds_read2_b32 v[32:33], v3 offset0:0 offset1:1
    ds_read2_b32 v[44:45], v4 offset0:0 offset1:1
    v_and_b32 v5, 1, v0
    v_cmp_eq_u32 vcc, 1, v5
    s_waitcnt lgkmcnt(0)
    v_add_f32 v32, v32, v44
    v_add_f32 v33, v33, v45
    v_cndmask_b32 v34, v32, v33, vcc
    v_cvt_pk_bf16_f32 v56, v33, v33
    v_cvt_pk_bf16_f32 v57, v33, v34
    v_cvt_pk_bf16_f32 v58, v32, v32
    v_cvt_pk_bf16_f32 v59, v32, v32
    v_cvt_pk_bf16_f32 v60, v33, v33
    v_cvt_pk_bf16_f32 v61, v34, v32
    v_cvt_pk_bf16_f32 v62, v32, v32
    v_cvt_pk_bf16_f32 v63, v32, v32
    v_add_u32 v3, -2048, v2
    ds_write_b128 v3, v[56:59]
    ds_write_b128 v3, v[60:63] offset:4160
    v_mov_b32 v6, 0
    v_mov_b32 v7, 0
    v_mov_b32 v8, 0
    v_mov_b32 v9, 0
    s_mul_i32 s21, s76, 4608
    s_add_u32 s21, s21, 68096
    v_lshl_add_u32 v3, v0, 4, s21
    s_mov_b32 exec_hi, 0
    ds_write_b128 v3, v[6:9]
    s_mov_b64 exec, -1
    s_branch L_exd_26
L_exb_25:
    v_lshl_add_u32 v3, v0, 3, s20
    ds_read_b64 v[32:33], v3 offset:1536
    ds_read_b32 v34, v3 offset:1544
    ds_read_b64 v[44:45], v3 offset:4144
    ds_read_b32 v46, v3 offset:4152
    s_waitcnt lgkmcnt(0)
    v_add_f32 v32, v32, v44
    v_add_f32 v33, v33, v45
    v_add_f32 v34, v34, v46
    v_cvt_pk_bf16_f32 v56, v34, v34
    v_cvt_pk_bf16_f32 v57, v33, v33
    v_cvt_pk_bf16_f32 v58, v33, v32
    v_cvt_pk_bf16_f32 v59, v32, v32
    v_cvt_pk_bf16_f32 v60, v34, v33
    v_cvt_pk_bf16_f32 v61, v33, v33
    v_cvt_pk_bf16_f32 v62, v32, v32
    v_cvt_pk_bf16_f32 v63, v32, v32
    v_add_u32 v3, -1024, v2
    ds_write_b128 v3, v[56:59]
    ds_write_b128 v3, v[60:63] offset:4160
    s_waitcnt vmcnt(63)
    s_barrier
    v_lshl_add_u32 v3, v0, 2, s20
    v_add_u32 v3, 2304, v3
    v_add_u32 v4, 2608, v3
    ds_read2_b32 v[32:33], v3 offset0:0 offset1:1
    ds_read2_b32 v[44:45], v4 offset0:0 offset1:1
    v_and_b32 v5, 1, v0
    v_cmp_eq_u32 vcc, 1, v5
    s_waitcnt lgkmcnt(0)
    v_add_f32 v32, v32, v44
    v_add_f32 v33, v33, v45
    v_cndmask_b32 v34, v32, v33, vcc
    v_cvt_pk_bf16_f32 v56, v33, v33
    v_cvt_pk_bf16_f32 v57, v33, v34
    v_cvt_pk_bf16_f32 v58, v32, v32
    v_cvt_pk_bf16_f32 v59, v32, v32
    v_cvt_pk_bf16_f32 v60, v33, v33
    v_cvt_pk_bf16_f32 v61, v34, v32
    v_cvt_pk_bf16_f32 v62, v32, v32
    v_cvt_pk_bf16_f32 v63, v32, v32
    v_add_u32 v3, -3072, v2
    ds_write_b128 v3, v[56:59]
    ds_write_b128 v3, v[60:63] offset:4160
    v_mov_b32 v6, 0
    v_mov_b32 v7, 0
    v_mov_b32 v8, 0
    v_mov_b32 v9, 0
    v_lshrrev_b32 v3, 2, v0
    v_mul_u32_u24 v3, 4160, v3
    v_and_b32 v4, 3, v0
    v_lshl_add_u32 v3, v4, 4, v3
    s_mul_i32 s21, s76, 8320
    s_add_u32 s21, s21, 4224
    v_add_u32 v3, s21, v3
    s_mov_b64 exec, 0xff
    ds_write_b128 v3, v[6:9]
    s_mov_b64 exec, -1
L_exd_26:
    v_and_b32 v3, 1, v0
    v_mul_u32_u24 v3, 4608, v3
    v_lshrrev_b32 v4, 1, v0
    v_lshl_add_u32 v3, v4, 4, v3
    s_lshl_b32 s21, s78, 10
    s_add_u32 s21, s21, 68608
    v_add_u32 v3, s21, v3
    s_waitcnt vmcnt(0)
    ds_write_b128 v3, v[12:15] offset:0
    ds_write_b128 v3, v[16:19] offset:512
    s_waitcnt lgkmcnt(0)
    s_mov_b32 s20, s42
    s_and_b32 s21, s43, 0xffff
    s_mov_b32 s22, 8388608
    s_mov_b32 s23, 0x20000
    s_lshl_b32 s72, s4, 3
    s_add_u32 s72, s72, s5
    s_lshl_b32 s72, s72, 2
    s_add_u32 s72, s72, s60
    s_lshl_b32 s72, s72, 13
    s_mul_i32 s73, s4, 0
    s_add_u32 s73, s73, 2560
    v_lshl_add_u32 v9, v0, 7, s73
    v_and_b32 v9, 4095, v9
    v_lshrrev_b32 v10, 5, v0
    v_lshl_add_u32 v9, v10, 12, v9
    s_mov_b32 exec_lo, 0x3f
    s_mov_b32 exec_hi, 0x3f
    buffer_load_dword v255, v9, s[20:23], s72 offen
    s_mov_b64 exec, -1
    v_and_b32 v14, 15, v0
    v_lshrrev_b32 v15, 4, v0
    v_lshlrev_b32 v16, 3, v15
    v_sub_u32 v16, v16, v14
    v_add_u32 v16, 2031, v16
    v_lshrrev_b32 v17, 1, v16
    v_lshlrev_b32 v17, 2, v17
    v_and_b32 v16, 1, v16
    v_mul_u32_u24 v16, 4160, v16
    v_add_u32 v16, v16, v17
    s_mul_i32 s20, s76, 8320
    s_lshl_b32 s21, s77, 6
    s_sub_u32 s20, s20, s21
    s_add_u32 s20, s20, 128
    s_sub_u32 s22, s20, 960
    v_add_u32 v4, s22, v16
    s_sub_u32 s22, s20, 1984
    v_add_u32 v5, s22, v16
    s_sub_u32 s22, s20, 3008
    v_add_u32 v6, s22, v16
    s_sub_u32 s22, s20, 4032
    v_add_u32 v7, s22, v16
    v_lshlrev_b32 v16, 5, v14
    v_lshl_add_u32 v16, v15, 4, v16
    s_mul_i32 s20, s76, 4608
    s_sub_u32 s20, s20, s21
    s_add_u32 s20, s20, 68192
    v_add_u32 v8, s20, v16
    s_barrier
    ds_read2_b32 v[44:45], v4 offset0:240 offset1:241
    ds_read2_b32 v[46:47], v4 offset0:242 offset1:243
    ds_read_b128 v[76:79], v8 offset:384
    ds_read2_b32 v[48:49], v4 offset0:112 offset1:113
    ds_read2_b32 v[50:51], v4 offset0:114 offset1:115
    ds_read_b128 v[80:83], v8 offset:896
    ds_read2_b32 v[52:53], v5 offset0:240 offset1:241
    ds_read2_b32 v[54:55], v5 offset0:242 offset1:243
    ds_read_b128 v[84:87], v8 offset:1408
    ds_read2_b32 v[56:57], v5 offset0:112 offset1:113
    ds_read2_b32 v[58:59], v5 offset0:114 offset1:115
    ds_read_b128 v[88:91], v8 offset:1920
    ds_read2_b32 v[60:61], v6 offset0:240 offset1:241
    ds_read2_b32 v[62:63], v6 offset0:242 offset1:243
    ds_read_b128 v[92:95], v8 offset:2432
    ds_read2_b32 v[64:65], v6 offset0:112 offset1:113
    ds_read2_b32 v[66:67], v6 offset0:114 offset1:115
    ds_read_b128 v[96:99], v8 offset:2944
    ds_read2_b32 v[68:69], v7 offset0:240 offset1:241
    ds_read2_b32 v[70:71], v7 offset0:242 offset1:243
    ds_read_b128 v[100:103], v8 offset:3456
    ds_read2_b32 v[72:73], v7 offset0:112 offset1:113
    ds_read2_b32 v[74:75], v7 offset0:114 offset1:115
    ds_read_b128 v[104:107], v8 offset:3968
    s_waitcnt lgkmcnt(0)
    v_mfma_f32_16x16x32_bf16 v[12:15], v[44:47], v[76:79], 0
    v_mfma_f32_16x16x32_bf16 v[16:19], v[44:47], v[80:83], 0
    v_mfma_f32_16x16x32_bf16 v[16:19], v[48:51], v[76:79], v[16:19]
    v_mfma_f32_16x16x32_bf16 v[20:23], v[44:47], v[84:87], 0
    v_mfma_f32_16x16x32_bf16 v[20:23], v[48:51], v[80:83], v[20:23]
    ds_read2_b32 v[108:109], v4 offset0:208 offset1:209
    v_mfma_f32_16x16x32_bf16 v[20:23], v[52:55], v[76:79], v[20:23]
    ds_read2_b32 v[110:111], v4 offset0:210 offset1:211
    v_mfma_f32_16x16x32_bf16 v[24:27], v[44:47], v[88:91], 0
    ds_read_b128 v[140:143], v8 offset:256
    v_mfma_f32_16x16x32_bf16 v[24:27], v[48:51], v[84:87], v[24:27]
    s_barrier
    ds_read2_b32 v[112:113], v4 offset0:80 offset1:81
    v_mfma_f32_16x16x32_bf16 v[24:27], v[52:55], v[80:83], v[24:27]
    ds_read2_b32 v[114:115], v4 offset0:82 offset1:83
    v_mfma_f32_16x16x32_bf16 v[24:27], v[56:59], v[76:79], v[24:27]
    ds_read_b128 v[144:147], v8 offset:768
    v_mfma_f32_16x16x32_bf16 v[28:31], v[44:47], v[92:95], 0
    ds_read2_b32 v[116:117], v5 offset0:208 offset1:209
    v_mfma_f32_16x16x32_bf16 v[28:31], v[48:51], v[88:91], v[28:31]
    ds_read2_b32 v[118:119], v5 offset0:210 offset1:211
    v_mfma_f32_16x16x32_bf16 v[28:31], v[52:55], v[84:87], v[28:31]
    ds_read_b128 v[148:151], v8 offset:1280
    v_mfma_f32_16x16x32_bf16 v[28:31], v[56:59], v[80:83], v[28:31]
    ds_read2_b32 v[120:121], v5 offset0:80 offset1:81
    v_mfma_f32_16x16x32_bf16 v[28:31], v[60:63], v[76:79], v[28:31]
    ds_read2_b32 v[122:123], v5 offset0:82 offset1:83
    v_mfma_f32_16x16x32_bf16 v[32:35], v[44:47], v[96:99], 0
    ds_read_b128 v[152:155], v8 offset:1792
    v_mfma_f32_16x16x32_bf16 v[32:35], v[48:51], v[92:95], v[32:35]
    ds_read2_b32 v[124:125], v6 offset0:208 offset1:209
    v_mfma_f32_16x16x32_bf16 v[32:35], v[52:55], v[88:91], v[32:35]
    ds_read2_b32 v[126:127], v6 offset0:210 offset1:211
    v_mfma_f32_16x16x32_bf16 v[32:35], v[56:59], v[84:87], v[32:35]
    ds_read_b128 v[156:159], v8 offset:2304
    v_mfma_f32_16x16x32_bf16 v[32:35], v[60:63], v[80:83], v[32:35]
    ds_read2_b32 v[128:129], v6 offset0:80 offset1:81
    v_mfma_f32_16x16x32_bf16 v[32:35], v[64:67], v[76:79], v[32:35]
    ds_read2_b32 v[130:131], v6 offset0:82 offset1:83
    v_mfma_f32_16x16x32_bf16 v[36:39], v[44:47], v[100:103], 0
    ds_read_b128 v[160:163], v8 offset:2816
    v_mfma_f32_16x16x32_bf16 v[36:39], v[48:51], v[96:99], v[36:39]
    ds_read2_b32 v[132:133], v7 offset0:208 offset1:209
    v_mfma_f32_16x16x32_bf16 v[36:39], v[52:55], v[92:95], v[36:39]
    ds_read2_b32 v[134:135], v7 offset0:210 offset1:211
    v_mfma_f32_16x16x32_bf16 v[36:39], v[56:59], v[88:91], v[36:39]
    s_waitcnt lgkmcnt(0)
    s_barrier
    ds_read_b128 v[164:167], v8 offset:3328
    v_mfma_f32_16x16x32_bf16 v[36:39], v[60:63], v[84:87], v[36:39]
    ds_read2_b32 v[136:137], v7 offset0:80 offset1:81
    v_mfma_f32_16x16x32_bf16 v[36:39], v[64:67], v[80:83], v[36:39]
    ds_read2_b32 v[138:139], v7 offset0:82 offset1:83
    v_mfma_f32_16x16x32_bf16 v[36:39], v[68:71], v[76:79], v[36:39]
    ds_read_b128 v[168:171], v8 offset:3840
    v_mfma_f32_16x16x32_bf16 v[40:43], v[44:47], v[104:107], 0
    v_mfma_f32_16x16x32_bf16 v[40:43], v[48:51], v[100:103], v[40:43]
    v_mfma_f32_16x16x32_bf16 v[40:43], v[52:55], v[96:99], v[40:43]
    v_mfma_f32_16x16x32_bf16 v[40:43], v[56:59], v[92:95], v[40:43]
    v_mfma_f32_16x16x32_bf16 v[40:43], v[60:63], v[88:91], v[40:43]
    v_mfma_f32_16x16x32_bf16 v[40:43], v[64:67], v[84:87], v[40:43]
    v_mfma_f32_16x16x32_bf16 v[40:43], v[68:71], v[80:83], v[40:43]
    v_mfma_f32_16x16x32_bf16 v[40:43], v[72:75], v[76:79], v[40:43]
    s_waitcnt lgkmcnt(0)
    v_mfma_f32_16x16x32_bf16 v[12:15], v[108:111], v[140:143], v[12:15]
    v_mfma_f32_16x16x32_bf16 v[16:19], v[108:111], v[144:147], v[16:19]
    v_mfma_f32_16x16x32_bf16 v[16:19], v[112:115], v[140:143], v[16:19]
    v_mfma_f32_16x16x32_bf16 v[20:23], v[108:111], v[148:151], v[20:23]
    v_mfma_f32_16x16x32_bf16 v[20:23], v[112:115], v[144:147], v[20:23]
    ds_read2_b32 v[44:45], v4 offset0:176 offset1:177
    v_mfma_f32_16x16x32_bf16 v[20:23], v[116:119], v[140:143], v[20:23]
    s_barrier
    s_mov_b32 s20, s42
    s_and_b32 s21, s43, 0xffff
    s_mov_b32 s22, 8388608
    s_mov_b32 s23, 0x20000
    s_lshl_b32 s72, s4, 3
    s_add_u32 s72, s72, s5
    s_lshl_b32 s72, s72, 2
    s_add_u32 s72, s72, s60
    s_lshl_b32 s72, s72, 13
    s_mul_i32 s73, s4, 0
    s_add_u32 s73, s73, 3328
    v_lshl_add_u32 v9, v0, 7, s73
    v_and_b32 v9, 4095, v9
    v_lshrrev_b32 v10, 5, v0
    v_lshl_add_u32 v9, v10, 12, v9
    s_mov_b32 exec_lo, 0x3f
    s_mov_b32 exec_hi, 0x3f
    buffer_load_dword v255, v9, s[20:23], s72 offen
    s_mov_b64 exec, -1
    ds_read2_b32 v[46:47], v4 offset0:178 offset1:179
    v_mfma_f32_16x16x32_bf16 v[24:27], v[108:111], v[152:155], v[24:27]
    ds_read_b128 v[76:79], v8 offset:128
    v_mfma_f32_16x16x32_bf16 v[24:27], v[112:115], v[148:151], v[24:27]
    ds_read2_b32 v[48:49], v4 offset0:48 offset1:49
    v_mfma_f32_16x16x32_bf16 v[24:27], v[116:119], v[144:147], v[24:27]
    ds_read2_b32 v[50:51], v4 offset0:50 offset1:51
    v_mfma_f32_16x16x32_bf16 v[24:27], v[120:123], v[140:143], v[24:27]
    ds_read_b128 v[80:83], v8 offset:640
    v_mfma_f32_16x16x32_bf16 v[28:31], v[108:111], v[156:159], v[28:31]
    ds_read2_b32 v[52:53], v5 offset0:176 offset1:177
    v_mfma_f32_16x16x32_bf16 v[28:31], v[112:115], v[152:155], v[28:31]
    ds_read2_b32 v[54:55], v5 offset0:178 offset1:179
    v_mfma_f32_16x16x32_bf16 v[28:31], v[116:119], v[148:151], v[28:31]
    ds_read_b128 v[84:87], v8 offset:1152
    v_mfma_f32_16x16x32_bf16 v[28:31], v[120:123], v[144:147], v[28:31]
    ds_read2_b32 v[56:57], v5 offset0:48 offset1:49
    v_mfma_f32_16x16x32_bf16 v[28:31], v[124:127], v[140:143], v[28:31]
    ds_read2_b32 v[58:59], v5 offset0:50 offset1:51
    v_mfma_f32_16x16x32_bf16 v[32:35], v[108:111], v[160:163], v[32:35]
    ds_read_b128 v[88:91], v8 offset:1664
    v_mfma_f32_16x16x32_bf16 v[32:35], v[112:115], v[156:159], v[32:35]
    ds_read2_b32 v[60:61], v6 offset0:176 offset1:177
    v_mfma_f32_16x16x32_bf16 v[32:35], v[116:119], v[152:155], v[32:35]
    ds_read2_b32 v[62:63], v6 offset0:178 offset1:179
    v_mfma_f32_16x16x32_bf16 v[32:35], v[120:123], v[148:151], v[32:35]
    ds_read_b128 v[92:95], v8 offset:2176
    v_mfma_f32_16x16x32_bf16 v[32:35], v[124:127], v[144:147], v[32:35]
    ds_read2_b32 v[64:65], v6 offset0:48 offset1:49
    v_mfma_f32_16x16x32_bf16 v[32:35], v[128:131], v[140:143], v[32:35]
    ds_read2_b32 v[66:67], v6 offset0:50 offset1:51
    v_mfma_f32_16x16x32_bf16 v[36:39], v[108:111], v[164:167], v[36:39]
    ds_read_b128 v[96:99], v8 offset:2688
    v_mfma_f32_16x16x32_bf16 v[36:39], v[112:115], v[160:163], v[36:39]
    s_barrier
    ds_read2_b32 v[68:69], v7 offset0:176 offset1:177
    v_mfma_f32_16x16x32_bf16 v[36:39], v[116:119], v[156:159], v[36:39]
    ds_read2_b32 v[70:71], v7 offset0:178 offset1:179
    v_mfma_f32_16x16x32_bf16 v[36:39], v[120:123], v[152:155], v[36:39]
    ds_read_b128 v[100:103], v8 offset:3200
    v_mfma_f32_16x16x32_bf16 v[36:39], v[124:127], v[148:151], v[36:39]
    ds_read2_b32 v[72:73], v7 offset0:48 offset1:49
    v_mfma_f32_16x16x32_bf16 v[36:39], v[128:131], v[144:147], v[36:39]
    ds_read2_b32 v[74:75], v7 offset0:50 offset1:51
    v_mfma_f32_16x16x32_bf16 v[36:39], v[132:135], v[140:143], v[36:39]
    ds_read_b128 v[104:107], v8 offset:3712
    v_mfma_f32_16x16x32_bf16 v[40:43], v[108:111], v[168:171], v[40:43]
    v_mfma_f32_16x16x32_bf16 v[40:43], v[112:115], v[164:167], v[40:43]
    v_mfma_f32_16x16x32_bf16 v[40:43], v[116:119], v[160:163], v[40:43]
    v_mfma_f32_16x16x32_bf16 v[40:43], v[120:123], v[156:159], v[40:43]
    v_mfma_f32_16x16x32_bf16 v[40:43], v[124:127], v[152:155], v[40:43]
    v_mfma_f32_16x16x32_bf16 v[40:43], v[128:131], v[148:151], v[40:43]
    v_mfma_f32_16x16x32_bf16 v[40:43], v[132:135], v[144:147], v[40:43]
    v_mfma_f32_16x16x32_bf16 v[40:43], v[136:139], v[140:143], v[40:43]
    s_waitcnt lgkmcnt(0)
    v_mfma_f32_16x16x32_bf16 v[12:15], v[44:47], v[76:79], v[12:15]
    v_mfma_f32_16x16x32_bf16 v[16:19], v[44:47], v[80:83], v[16:19]
    v_mfma_f32_16x16x32_bf16 v[16:19], v[48:51], v[76:79], v[16:19]
    v_mfma_f32_16x16x32_bf16 v[20:23], v[44:47], v[84:87], v[20:23]
    s_barrier
    v_mfma_f32_16x16x32_bf16 v[20:23], v[48:51], v[80:83], v[20:23]
    ds_read2_b32 v[108:109], v4 offset0:144 offset1:145
    v_mfma_f32_16x16x32_bf16 v[20:23], v[52:55], v[76:79], v[20:23]
    ds_read2_b32 v[110:111], v4 offset0:146 offset1:147
    v_mfma_f32_16x16x32_bf16 v[24:27], v[44:47], v[88:91], v[24:27]
    ds_read_b128 v[140:143], v8 offset:0
    v_mfma_f32_16x16x32_bf16 v[24:27], v[48:51], v[84:87], v[24:27]
    ds_read2_b32 v[112:113], v4 offset0:16 offset1:17
    v_mfma_f32_16x16x32_bf16 v[24:27], v[52:55], v[80:83], v[24:27]
    ds_read2_b32 v[114:115], v4 offset0:18 offset1:19
    v_mfma_f32_16x16x32_bf16 v[24:27], v[56:59], v[76:79], v[24:27]
    ds_read_b128 v[144:147], v8 offset:512
    v_mfma_f32_16x16x32_bf16 v[28:31], v[44:47], v[92:95], v[28:31]
    ds_read2_b32 v[116:117], v5 offset0:144 offset1:145
    v_mfma_f32_16x16x32_bf16 v[28:31], v[48:51], v[88:91], v[28:31]
    ds_read2_b32 v[118:119], v5 offset0:146 offset1:147
    v_mfma_f32_16x16x32_bf16 v[28:31], v[52:55], v[84:87], v[28:31]
    ds_read_b128 v[148:151], v8 offset:1024
    v_mfma_f32_16x16x32_bf16 v[28:31], v[56:59], v[80:83], v[28:31]
    ds_read2_b32 v[120:121], v5 offset0:16 offset1:17
    v_mfma_f32_16x16x32_bf16 v[28:31], v[60:63], v[76:79], v[28:31]
    ds_read2_b32 v[122:123], v5 offset0:18 offset1:19
    v_mfma_f32_16x16x32_bf16 v[32:35], v[44:47], v[96:99], v[32:35]
    ds_read_b128 v[152:155], v8 offset:1536
    v_mfma_f32_16x16x32_bf16 v[32:35], v[48:51], v[92:95], v[32:35]
    ds_read2_b32 v[124:125], v6 offset0:144 offset1:145
    v_mfma_f32_16x16x32_bf16 v[32:35], v[52:55], v[88:91], v[32:35]
    ds_read2_b32 v[126:127], v6 offset0:146 offset1:147
    v_mfma_f32_16x16x32_bf16 v[32:35], v[56:59], v[84:87], v[32:35]
    ds_read_b128 v[156:159], v8 offset:2048
    v_mfma_f32_16x16x32_bf16 v[32:35], v[60:63], v[80:83], v[32:35]
    ds_read2_b32 v[128:129], v6 offset0:16 offset1:17
    v_mfma_f32_16x16x32_bf16 v[32:35], v[64:67], v[76:79], v[32:35]
    s_barrier
    ds_read2_b32 v[130:131], v6 offset0:18 offset1:19
    v_mfma_f32_16x16x32_bf16 v[36:39], v[44:47], v[100:103], v[36:39]
    ds_read_b128 v[160:163], v8 offset:2560
    v_mfma_f32_16x16x32_bf16 v[36:39], v[48:51], v[96:99], v[36:39]
    ds_read2_b32 v[132:133], v7 offset0:144 offset1:145
    v_mfma_f32_16x16x32_bf16 v[36:39], v[52:55], v[92:95], v[36:39]
    ds_read2_b32 v[134:135], v7 offset0:146 offset1:147
    v_mfma_f32_16x16x32_bf16 v[36:39], v[56:59], v[88:91], v[36:39]
    ds_read_b128 v[164:167], v8 offset:3072
    v_mfma_f32_16x16x32_bf16 v[36:39], v[60:63], v[84:87], v[36:39]
    ds_read2_b32 v[136:137], v7 offset0:16 offset1:17
    v_mfma_f32_16x16x32_bf16 v[36:39], v[64:67], v[80:83], v[36:39]
    ds_read2_b32 v[138:139], v7 offset0:18 offset1:19
    v_mfma_f32_16x16x32_bf16 v[36:39], v[68:71], v[76:79], v[36:39]
    ds_read_b128 v[168:171], v8 offset:3584
    v_mfma_f32_16x16x32_bf16 v[40:43], v[44:47], v[104:107], v[40:43]
    v_mfma_f32_16x16x32_bf16 v[40:43], v[48:51], v[100:103], v[40:43]
    v_mfma_f32_16x16x32_bf16 v[40:43], v[52:55], v[96:99], v[40:43]
    v_mfma_f32_16x16x32_bf16 v[40:43], v[56:59], v[92:95], v[40:43]
    v_mfma_f32_16x16x32_bf16 v[40:43], v[60:63], v[88:91], v[40:43]
    v_mfma_f32_16x16x32_bf16 v[40:43], v[64:67], v[84:87], v[40:43]
    v_mfma_f32_16x16x32_bf16 v[40:43], v[68:71], v[80:83], v[40:43]
    v_mfma_f32_16x16x32_bf16 v[40:43], v[72:75], v[76:79], v[40:43]
    s_waitcnt lgkmcnt(0)
    v_mfma_f32_16x16x32_bf16 v[12:15], v[108:111], v[140:143], v[12:15]
    v_mfma_f32_16x16x32_bf16 v[16:19], v[108:111], v[144:147], v[16:19]
    s_barrier
    s_mov_b32 s20, s46
    s_and_b32 s21, s47, 0xffff
    s_mov_b32 s22, 917504
    s_mov_b32 s23, 0x20000
    s_lshr_b32 s72, s2, 3
    s_lshl_b32 s72, s72, 2
    s_add_u32 s72, s72, s60
    s_mul_i32 s72, s72, 7168
    s_add_u32 s72, s72, 384
    v_lshlrev_b32 v9, 10, v0
    s_mov_b64 exec, 0x7f
    buffer_load_dword v255, v9, s[20:23], s72 offen
    s_mov_b64 exec, -1
    v_mfma_f32_16x16x32_bf16 v[16:19], v[112:115], v[140:143], v[16:19]
    v_mfma_f32_16x16x32_bf16 v[20:23], v[108:111], v[148:151], v[20:23]
    v_mfma_f32_16x16x32_bf16 v[20:23], v[112:115], v[144:147], v[20:23]
    v_mfma_f32_16x16x32_bf16 v[20:23], v[116:119], v[140:143], v[20:23]
    v_mfma_f32_16x16x32_bf16 v[24:27], v[108:111], v[152:155], v[24:27]
    v_mfma_f32_16x16x32_bf16 v[24:27], v[112:115], v[148:151], v[24:27]
    v_mfma_f32_16x16x32_bf16 v[24:27], v[116:119], v[144:147], v[24:27]
    v_mfma_f32_16x16x32_bf16 v[24:27], v[120:123], v[140:143], v[24:27]
    v_mfma_f32_16x16x32_bf16 v[28:31], v[108:111], v[156:159], v[28:31]
    v_mfma_f32_16x16x32_bf16 v[28:31], v[112:115], v[152:155], v[28:31]
    v_mfma_f32_16x16x32_bf16 v[28:31], v[116:119], v[148:151], v[28:31]
    v_mfma_f32_16x16x32_bf16 v[28:31], v[120:123], v[144:147], v[28:31]
    v_mfma_f32_16x16x32_bf16 v[28:31], v[124:127], v[140:143], v[28:31]
    v_mfma_f32_16x16x32_bf16 v[32:35], v[108:111], v[160:163], v[32:35]
    v_mfma_f32_16x16x32_bf16 v[32:35], v[112:115], v[156:159], v[32:35]
    v_mfma_f32_16x16x32_bf16 v[32:35], v[116:119], v[152:155], v[32:35]
    v_mfma_f32_16x16x32_bf16 v[32:35], v[120:123], v[148:151], v[32:35]
    s_barrier
    v_mfma_f32_16x16x32_bf16 v[32:35], v[124:127], v[144:147], v[32:35]
    v_mfma_f32_16x16x32_bf16 v[32:35], v[128:131], v[140:143], v[32:35]
    v_mfma_f32_16x16x32_bf16 v[36:39], v[108:111], v[164:167], v[36:39]
    v_mfma_f32_16x16x32_bf16 v[36:39], v[112:115], v[160:163], v[36:39]
    v_mfma_f32_16x16x32_bf16 v[36:39], v[116:119], v[156:159], v[36:39]
    v_mfma_f32_16x16x32_bf16 v[36:39], v[120:123], v[152:155], v[36:39]
    v_mfma_f32_16x16x32_bf16 v[36:39], v[124:127], v[148:151], v[36:39]
    v_mfma_f32_16x16x32_bf16 v[36:39], v[128:131], v[144:147], v[36:39]
    v_mfma_f32_16x16x32_bf16 v[36:39], v[132:135], v[140:143], v[36:39]
    v_mfma_f32_16x16x32_bf16 v[40:43], v[108:111], v[168:171], v[40:43]
    v_mfma_f32_16x16x32_bf16 v[40:43], v[112:115], v[164:167], v[40:43]
    v_mfma_f32_16x16x32_bf16 v[40:43], v[116:119], v[160:163], v[40:43]
    v_mfma_f32_16x16x32_bf16 v[40:43], v[120:123], v[156:159], v[40:43]
    v_mfma_f32_16x16x32_bf16 v[40:43], v[124:127], v[152:155], v[40:43]
    v_mfma_f32_16x16x32_bf16 v[40:43], v[128:131], v[148:151], v[40:43]
    v_mfma_f32_16x16x32_bf16 v[40:43], v[132:135], v[144:147], v[40:43]
    v_mfma_f32_16x16x32_bf16 v[40:43], v[136:139], v[140:143], v[40:43]
    s_barrier
    s_cmp_eq_u32 s5, 7
    s_cbranch_scc0 L_zg_27
    s_mul_i32 s20, s4, 14336
    s_lshl_b32 s21, s78, 10
    s_add_u32 s20, s20, s21
    s_add_u32 s20, s20, 13631488
    v_lshlrev_b32 v10, 4, v0
    buffer_load_dwordx4 v[172:175], v10, s[16:19], s20 offen sc1
    s_add_u32 s20, s20, 4096
    buffer_load_dwordx4 v[176:179], v10, s[16:19], s20 offen sc1
    s_add_u32 s20, s20, 4096
    buffer_load_dwordx4 v[180:183], v10, s[16:19], s20 offen sc1
    s_add_u32 s20, s20, 4096
    buffer_load_dwordx4 v[184:187], v10, s[16:19], s20 offen sc1
    s_add_u32 s20, s20, 4096
L_zg_27:
    s_lshl_b32 s20, s78, 12
    s_add_u32 s20, s20, 16896
    v_lshl_add_u32 v1, v0, 4, s20
    s_cmp_eq_u32 s77, 1
    s_cbranch_scc1 L_cx_28
    ds_write_b128 v1, v[28:31] offset:0
    ds_write_b128 v1, v[32:35] offset:1024
    ds_write_b128 v1, v[36:39] offset:2048
    ds_write_b128 v1, v[40:43] offset:3072
    s_branch L_cxd_29
L_cx_28:
    ds_write_b128 v1, v[12:15] offset:0
    ds_write_b128 v1, v[16:19] offset:1024
    ds_write_b128 v1, v[20:23] offset:2048
    ds_write_b128 v1, v[24:27] offset:3072
    v_mov_b32 v12, v28
    v_mov_b32 v13, v29
    v_mov_b32 v14, v30
    v_mov_b32 v15, v31
    v_mov_b32 v16, v32
    v_mov_b32 v17, v33
    v_mov_b32 v18, v34
    v_mov_b32 v19, v35
    v_mov_b32 v20, v36
    v_mov_b32 v21, v37
    v_mov_b32 v22, v38
    v_mov_b32 v23, v39
    v_mov_b32 v24, v40
    v_mov_b32 v25, v41
    v_mov_b32 v26, v42
    v_mov_b32 v27, v43
L_cxd_29:
    s_waitcnt lgkmcnt(0)
    s_barrier
    s_xor_b32 s20, s78, 1
    s_lshl_b32 s20, s20, 12
    s_add_u32 s20, s20, 16896
    v_lshl_add_u32 v1, v0, 4, s20
    ds_read_b128 v[44:47], v1 offset:0
    ds_read_b128 v[48:51], v1 offset:1024
    ds_read_b128 v[52:55], v1 offset:2048
    ds_read_b128 v[56:59], v1 offset:3072
    v_and_b32 v10, 15, v0
    v_lshrrev_b32 v11, 4, v0
    v_lshlrev_b32 v10, 5, v10
    v_lshl_add_u32 v10, v11, 3, v10
    s_mul_i32 s20, s76, 4608
    s_lshl_b32 s21, s77, 11
    s_add_u32 s20, s20, s21
    s_add_u32 s20, s20, 68608
    v_add_u32 v2, s20, v10
    ds_read_b64 v[60:61], v2 offset:0
    ds_read_b64 v[62:63], v2 offset:512
    ds_read_b64 v[64:65], v2 offset:1024
    ds_read_b64 v[66:67], v2 offset:1536
    s_lshl_b32 s20, s78, 11
    s_add_u32 s20, s20, 33280
    v_add_u32 v3, s20, v10
    v_lshl_add_u32 v4, v0, 4, s20
    s_waitcnt lgkmcnt(4)
    v_add_f32 v12, v12, v44
    v_add_f32 v13, v13, v45
    v_add_f32 v14, v14, v46
    v_add_f32 v15, v15, v47
    v_add_f32 v16, v16, v48
    v_add_f32 v17, v17, v49
    v_add_f32 v18, v18, v50
    v_add_f32 v19, v19, v51
    v_add_f32 v20, v20, v52
    v_add_f32 v21, v21, v53
    v_add_f32 v22, v22, v54
    v_add_f32 v23, v23, v55
    v_add_f32 v24, v24, v56
    v_add_f32 v25, v25, v57
    v_add_f32 v26, v26, v58
    v_add_f32 v27, v27, v59
    s_waitcnt lgkmcnt(0)
    v_lshlrev_b32 v68, 16, v60
    v_and_b32 v69, 0xffff0000, v60
    v_lshlrev_b32 v70, 16, v61
    v_and_b32 v71, 0xffff0000, v61
    v_lshlrev_b32 v72, 16, v62
    v_and_b32 v73, 0xffff0000, v62
    v_lshlrev_b32 v74, 16, v63
    v_and_b32 v75, 0xffff0000, v63
    v_lshlrev_b32 v76, 16, v64
    v_and_b32 v77, 0xffff0000, v64
    v_lshlrev_b32 v78, 16, v65
    v_and_b32 v79, 0xffff0000, v65
    v_lshlrev_b32 v80, 16, v66
    v_and_b32 v81, 0xffff0000, v66
    v_lshlrev_b32 v82, 16, v67
    v_and_b32 v83, 0xffff0000, v67
    v_fmac_f32 v12, s58, v68
    v_fmac_f32 v13, s58, v69
    v_fmac_f32 v14, s58, v70
    v_fmac_f32 v15, s58, v71
    v_fmac_f32 v16, s58, v72
    v_fmac_f32 v17, s58, v73
    v_fmac_f32 v18, s58, v74
    v_fmac_f32 v19, s58, v75
    v_fmac_f32 v20, s58, v76
    v_fmac_f32 v21, s58, v77
    v_fmac_f32 v22, s58, v78
    v_fmac_f32 v23, s58, v79
    v_fmac_f32 v24, s58, v80
    v_fmac_f32 v25, s58, v81
    v_fmac_f32 v26, s58, v82
    v_fmac_f32 v27, s58, v83
    v_cvt_pk_bf16_f32 v60, v12, v13
    v_cvt_pk_bf16_f32 v61, v14, v15
    ds_write_b64 v3, v[60:61] offset:0
    v_cvt_pk_bf16_f32 v62, v16, v17
    v_cvt_pk_bf16_f32 v63, v18, v19
    ds_write_b64 v3, v[62:63] offset:512
    v_cvt_pk_bf16_f32 v64, v20, v21
    v_cvt_pk_bf16_f32 v65, v22, v23
    ds_write_b64 v3, v[64:65] offset:1024
    v_cvt_pk_bf16_f32 v66, v24, v25
    v_cvt_pk_bf16_f32 v67, v26, v27
    ds_write_b64 v3, v[66:67] offset:1536
    ds_read_b128 v[44:47], v4 offset:0
    ds_read_b128 v[48:51], v4 offset:1024
    s_lshl_b32 s20, s68, 11
    s_lshl_b32 s21, s78, 11
    s_add_u32 s20, s20, s21
    s_add_u32 s20, s20, 11534336
    v_lshlrev_b32 v1, 4, v0
    s_waitcnt lgkmcnt(1)
    buffer_store_dwordx4 v[44:47], v1, s[16:19], s20 offen offset:0 sc1
    s_waitcnt lgkmcnt(0)
    buffer_store_dwordx4 v[48:51], v1, s[16:19], s20 offen offset:1024 sc1
    s_waitcnt vmcnt(2)
    s_cmp_eq_u32 s5, 7
    s_cbranch_scc0 L_zs_30
    v_and_b32 v3, 15, v0
    v_lshrrev_b32 v4, 3, v3
    v_mul_u32_u24 v4, 3584, v4
    v_bfe_u32 v5, v0, 2, 1
    v_lshlrev_b32 v5, 3, v5
    v_and_b32 v6, 3, v0
    v_and_b32 v7, 48, v0
    v_add3_u32 v5, v5, v6, v7
    v_lshl_add_u32 v4, v5, 3, v4
    s_and_b32 s20, s78, 1
    s_mul_i32 s20, s20, 7168
    s_lshr_b32 s21, s78, 1
    s_lshl_b32 s21, s21, 9
    s_add_u32 s20, s20, s21
    s_add_u32 s20, s20, 147456
    v_add_u32 v4, s20, v4
    ds_write_b64 v4, v[172:173] offset:0
    ds_write_b64 v4, v[174:175] offset:32
    ds_write_b64 v4, v[176:177] offset:1024
    ds_write_b64 v4, v[178:179] offset:1056
    ds_write_b64 v4, v[180:181] offset:2048
    ds_write_b64 v4, v[182:183] offset:2080
    s_cmp_lt_u32 s78, 2
    s_cbranch_scc0 L_zs_30
    ds_write_b64 v4, v[184:185] offset:3072
    ds_write_b64 v4, v[186:187] offset:3104
L_zs_30:
    s_waitcnt lgkmcnt(0)
    s_barrier
    s_waitcnt vmcnt(0)
    s_mov_b32 s12, s46
    s_and_b32 s13, s47, 0xffff
    s_mov_b32 s14, 917504
    s_mov_b32 s15, 0x20000
    v_lshrrev_b32 v2, 3, v0
    v_bfe_u32 v3, v0, 4, 2
    v_lshlrev_b32 v3, 1, v3
    v_and_b32 v4, 7, v0
    v_xor_b32 v3, v3, v4
    v_lshlrev_b32 v3, 4, v3
    v_lshl_add_u32 v1, v2, 10, v3
    s_and_b32 s72, s78, 1
    s_lshl_b32 s72, s72, 13
    s_lshl_b32 s22, s38, 7
    s_add_u32 s72, s72, s22
    s_lshr_b32 s23, s78, 1
    s_lshl_b32 s23, s23, 14
    s_lshl_b32 s73, s78, 10
    s_mul_i32 s20, s23, 1
    s_add_u32 s20, s20, 0
    s_add_u32 m0, s73, 0
    s_add_u32 s20, s20, s72
    buffer_load_dwordx4 v1, s[12:15], s20 offen lds
    s_mul_i32 s20, s23, 1
    s_add_u32 s20, s20, 32768
    s_add_u32 m0, s73, 4096
    s_add_u32 s20, s20, s72
    buffer_load_dwordx4 v1, s[12:15], s20 offen lds
    s_mul_i32 s20, s23, 1
    s_add_u32 s20, s20, 65536
    s_add_u32 m0, s73, 8192
    s_add_u32 s20, s20, s72
    buffer_load_dwordx4 v1, s[12:15], s20 offen lds
    s_mul_i32 s20, s23, 2
    s_add_u32 s20, s20, 98304
    s_add_u32 m0, s73, 12288
    s_add_u32 s20, s20, s72
    buffer_load_dwordx4 v1, s[12:15], s20 offen lds
    s_barrier
    s_cmp_eq_u32 s3, 4
    s_cbranch_scc0 L_nf_31
    s_lshl_b32 s20, s5, 5
    s_add_u32 s20, s20, s4
    s_lshl_b32 s20, s20, 7
    s_add_u32 s20, s20, 425984
    v_mov_b32 v200, s6
    v_mov_b32 v201, s7
    v_mov_b32 v202, 0
    s_mov_b64 exec, 1
    buffer_store_dwordx2 v[200:201], v202, s[16:19], s20 offen sc1
    s_mov_b64 exec, -1
L_nf_31:
    s_mul_i32 s20, s23, 1
    s_add_u32 s20, s20, 147456
    s_add_u32 m0, s73, 16384
    s_add_u32 s20, s20, s72
    buffer_load_dwordx4 v1, s[12:15], s20 offen lds
    s_mul_i32 s20, s23, 1
    s_add_u32 s20, s20, 180224
    s_add_u32 m0, s73, 20480
    s_add_u32 s20, s20, s72
    buffer_load_dwordx4 v1, s[12:15], s20 offen lds
    s_mul_i32 s20, s23, 1
    s_add_u32 s20, s20, 212992
    s_add_u32 m0, s73, 24576
    s_add_u32 s20, s20, s72
    buffer_load_dwordx4 v1, s[12:15], s20 offen lds
    s_mul_i32 s20, s23, 1
    s_add_u32 s20, s20, 262144
    s_add_u32 m0, s73, 28672
    s_add_u32 s20, s20, s72
    buffer_load_dwordx4 v1, s[12:15], s20 offen lds
    s_mul_i32 s20, s23, 1
    s_add_u32 s20, s20, 294912
    s_add_u32 m0, s73, 32768
    s_add_u32 s20, s20, s72
    buffer_load_dwordx4 v1, s[12:15], s20 offen lds
    s_mul_i32 s20, s23, 1
    s_add_u32 s20, s20, 327680
    s_add_u32 m0, s73, 36864
    s_add_u32 s20, s20, s72
    buffer_load_dwordx4 v1, s[12:15], s20 offen lds
    s_mul_i32 s20, s23, 2
    s_add_u32 s20, s20, 360448
    s_add_u32 m0, s73, 40960
    s_add_u32 s20, s20, s72
    buffer_load_dwordx4 v1, s[12:15], s20 offen lds
    s_mul_i32 s20, s23, 1
    s_add_u32 s20, s20, 409600
    s_add_u32 m0, s73, 45056
    s_add_u32 s20, s20, s72
    buffer_load_dwordx4 v1, s[12:15], s20 offen lds
    s_mul_i32 s20, s23, 1
    s_add_u32 s20, s20, 442368
    s_add_u32 m0, s73, 49152
    s_add_u32 s20, s20, s72
    buffer_load_dwordx4 v1, s[12:15], s20 offen lds
    s_mul_i32 s20, s23, 1
    s_add_u32 s20, s20, 475136
    s_add_u32 m0, s73, 53248
    s_add_u32 s20, s20, s72
    buffer_load_dwordx4 v1, s[12:15], s20 offen lds
    s_mul_i32 s20, s23, 1
    s_add_u32 s20, s20, 524288
    s_add_u32 m0, s73, 57344
    s_add_u32 s20, s20, s72
    buffer_load_dwordx4 v1, s[12:15], s20 offen lds
    s_mul_i32 s20, s23, 1
    s_add_u32 s20, s20, 557056
    s_add_u32 m0, s73, 61440
    s_add_u32 s20, s20, s72
    buffer_load_dwordx4 v1, s[12:15], s20 offen lds
    s_barrier
    s_mul_i32 s20, s23, 1
    s_add_u32 s20, s20, 589824
    s_add_u32 m0, s73, 65536
    s_add_u32 s20, s20, s72
    buffer_load_dwordx4 v1, s[12:15], s20 offen lds
    s_mul_i32 s20, s23, 2
    s_add_u32 s20, s20, 622592
    s_add_u32 m0, s73, 69632
    s_add_u32 s20, s20, s72
    buffer_load_dwordx4 v1, s[12:15], s20 offen lds
    s_mul_i32 s20, s23, 1
    s_add_u32 s20, s20, 671744
    s_add_u32 m0, s73, 73728
    s_add_u32 s20, s20, s72
    buffer_load_dwordx4 v1, s[12:15], s20 offen lds
    s_mul_i32 s20, s23, 1
    s_add_u32 s20, s20, 704512
    s_add_u32 m0, s73, 77824
    s_add_u32 s20, s20, s72
    buffer_load_dwordx4 v1, s[12:15], s20 offen lds
    s_mul_i32 s20, s23, 1
    s_add_u32 s20, s20, 737280
    s_add_u32 m0, s73, 81920
    s_add_u32 s20, s20, s72
    buffer_load_dwordx4 v1, s[12:15], s20 offen lds
    s_mul_i32 s20, s23, 1
    s_add_u32 s20, s20, 786432
    s_add_u32 m0, s73, 86016
    s_add_u32 s20, s20, s72
    buffer_load_dwordx4 v1, s[12:15], s20 offen lds
    s_mul_i32 s20, s23, 1
    s_add_u32 s20, s20, 819200
    s_add_u32 m0, s73, 90112
    s_add_u32 s20, s20, s72
    buffer_load_dwordx4 v1, s[12:15], s20 offen lds
    s_mul_i32 s20, s23, 1
    s_add_u32 s20, s20, 851968
    s_add_u32 m0, s73, 94208
    s_add_u32 s20, s20, s72
    buffer_load_dwordx4 v1, s[12:15], s20 offen lds
    s_mul_i32 s20, s23, -47
    s_add_u32 s20, s20, 884736
    s_add_u32 m0, s73, 98304
    s_add_u32 s20, s20, s72
    buffer_load_dwordx4 v1, s[12:15], s20 offen lds
    s_mul_i32 s20, s23, 8
    s_add_u32 s20, s20, 245760
    s_add_u32 m0, s73, 102400
    s_add_u32 s20, s20, s72
    buffer_load_dwordx4 v1, s[12:15], s20 offen lds
    s_mul_i32 s20, s23, 8
    s_add_u32 s20, s20, 507904
    s_add_u32 m0, s73, 106496
    s_add_u32 s20, s20, s72
    buffer_load_dwordx4 v1, s[12:15], s20 offen lds
    s_mul_i32 s20, s23, 8
    s_add_u32 s20, s20, 770048
    s_add_u32 m0, s73, 110592
    s_add_u32 s20, s20, s72
    buffer_load_dwordx4 v1, s[12:15], s20 offen lds
    s_waitcnt vmcnt(0)
L_x2:
    s_barrier
    v_lshrrev_b32 v7, 4, v0
    v_bfe_u32 v8, v0, 2, 2
    v_and_b32 v9, 3, v0
    v_lshl_add_u32 v10, v7, 2, v8
    v_bfe_u32 v11, v10, 1, 2
    v_lshlrev_b32 v10, 7, v10
    v_lshl_add_u32 v10, v9, 3, v10
    s_mul_i32 s20, s59, 57344
    v_xor_b32 v9, 0, v11
    v_lshl_add_u32 v9, v9, 5, v10
    v_add_u32 v1, s20, v9
    v_xor_b32 v9, 1, v11
    v_lshl_add_u32 v9, v9, 5, v10
    v_add_u32 v2, s20, v9
    v_xor_b32 v9, 2, v11
    v_lshl_add_u32 v9, v9, 5, v10
    v_add_u32 v3, s20, v9
    v_xor_b32 v9, 3, v11
    v_lshl_add_u32 v9, v9, 5, v10
    v_add_u32 v4, s20, v9
    v_xor_b32 v9, s60, v11
    v_lshl_add_u32 v9, v9, 5, v10
    s_lshl_b32 s20, s59, 12
    s_add_u32 s20, s20, 114688
    v_add_u32 v250, s20, v9
    v_lshlrev_b32 v5, 4, v0
    v_and_b32 v6, 31, v0
    v_lshlrev_b32 v6, 4, v6
    v_lshrrev_b32 v7, 5, v0
    v_lshl_add_u32 v6, v7, 11, v6
    s_lshl_b32 s21, s4, 3
    s_lshl_b32 s22, s59, 2
    s_add_u32 s22, s21, s22
    s_lshl_b32 s21, s22, 9
    s_add_u32 s21, s21, 524288
    v_and_b32 v7, 31, v0
    v_lshlrev_b32 v7, 7, v7
    s_mul_i32 s72, s22, 12288
    s_mul_i32 s73, s60, 3072
    s_add_u32 s72, s72, s73
    s_add_u32 s72, s72, 7340032
    s_lshl_b32 s73, s22, 11
    s_lshl_b32 s23, s60, 9
    s_add_u32 s73, s73, s23
    s_add_u32 s73, s73, 10485760
    v_lshrrev_b32 v8, 3, v0
    v_and_b32 v9, 7, v0
    v_lshlrev_b32 v10, 12, v8
    v_lshl_add_u32 v252, v9, 4, v10
    s_lshl_b32 s69, s38, 18
    s_lshl_b32 s23, s3, 15
    s_add_u32 s69, s69, s23
    s_lshl_b32 s23, s4, 7
    s_add_u32 s69, s69, s23
    s_add_u32 s69, s69, 11534336
    v_bfe_u32 v10, v0, 4, 2
    v_lshlrev_b32 v10, 1, v10
    v_xor_b32 v10, v10, v9
    v_lshlrev_b32 v10, 4, v10
    v_lshl_add_u32 v10, v8, 7, v10
    s_lshl_b32 s22, s3, 10
    s_add_u32 s22, s22, 114688
    v_add_u32 v251, s22, v10
    s_lshl_b32 s23, s38, 12
    s_add_u32 s23, s23, 425984
    v_add_u32 v10, s23, v7
    v_add_u32 v7, s21, v7
    v_cmp_gt_u32 vcc, 32, v0
    s_nop 1
    v_cndmask_b32 v7, v7, v10, vcc
    v_mov_b32 v8, s6
    v_mov_b32 v9, s7
    ds_read_b64_tr_b16 v[84:85], v1 offset:0
    ds_read_b64_tr_b16 v[86:87], v1 offset:2048
    ds_read_b64_tr_b16 v[88:89], v2 offset:0
    ds_read_b64_tr_b16 v[90:91], v2 offset:2048
    ds_read_b64_tr_b16 v[92:93], v3 offset:0
    ds_read_b64_tr_b16 v[94:95], v3 offset:2048
    ds_read_b64_tr_b16 v[96:97], v4 offset:0
    ds_read_b64_tr_b16 v[98:99], v4 offset:2048
    s_mov_b32 exec_hi, 0xffff
    buffer_load_dwordx2 v[8:9], v7, s[16:19], 0 offen sc1
    s_mov_b64 exec, -1
    ds_read_b64_tr_b16 v[100:101], v1 offset:4096
    ds_read_b64_tr_b16 v[102:103], v1 offset:6144
    ds_read_b64_tr_b16 v[104:105], v2 offset:4096
    ds_read_b64_tr_b16 v[106:107], v2 offset:6144
    ds_read_b64_tr_b16 v[108:109], v3 offset:4096
    ds_read_b64_tr_b16 v[110:111], v3 offset:6144
    ds_read_b64_tr_b16 v[112:113], v4 offset:4096
    ds_read_b64_tr_b16 v[114:115], v4 offset:6144
    ds_read_b64_tr_b16 v[116:117], v1 offset:8192
    ds_read_b64_tr_b16 v[118:119], v1 offset:10240
    ds_read_b64_tr_b16 v[120:121], v2 offset:8192
    ds_read_b64_tr_b16 v[122:123], v2 offset:10240
    ds_read_b64_tr_b16 v[124:125], v3 offset:8192
    ds_read_b64_tr_b16 v[126:127], v3 offset:10240
    ds_read_b64_tr_b16 v[128:129], v4 offset:8192
    ds_read_b64_tr_b16 v[130:131], v4 offset:10240
    ds_read_b64_tr_b16 v[132:133], v1 offset:14336
    ds_read_b64_tr_b16 v[134:135], v1 offset:16384
    ds_read_b64_tr_b16 v[136:137], v2 offset:14336
    ds_read_b64_tr_b16 v[138:139], v2 offset:16384
    ds_read_b64_tr_b16 v[140:141], v3 offset:14336
    ds_read_b64_tr_b16 v[142:143], v3 offset:16384
    ds_read_b64_tr_b16 v[144:145], v4 offset:14336
    ds_read_b64_tr_b16 v[146:147], v4 offset:16384
    ds_read_b64_tr_b16 v[148:149], v1 offset:18432
    ds_read_b64_tr_b16 v[150:151], v1 offset:20480
    ds_read_b64_tr_b16 v[152:153], v2 offset:18432
    ds_read_b64_tr_b16 v[154:155], v2 offset:20480
    ds_read_b64_tr_b16 v[156:157], v3 offset:18432
    ds_read_b64_tr_b16 v[158:159], v3 offset:20480
    ds_read_b64_tr_b16 v[160:161], v4 offset:18432
    ds_read_b64_tr_b16 v[162:163], v4 offset:20480
    ds_read_b64_tr_b16 v[164:165], v1 offset:22528
    ds_read_b64_tr_b16 v[166:167], v1 offset:24576
    ds_read_b64_tr_b16 v[168:169], v2 offset:22528
    ds_read_b64_tr_b16 v[170:171], v2 offset:24576
    ds_read_b64_tr_b16 v[172:173], v3 offset:22528
    ds_read_b64_tr_b16 v[174:175], v3 offset:24576
    ds_read_b64_tr_b16 v[176:177], v4 offset:22528
    ds_read_b64_tr_b16 v[178:179], v4 offset:24576
    ds_read_b64_tr_b16 v[180:181], v1 offset:12288
    ds_read_b64_tr_b16 v[182:183], v1 offset:26624
    ds_read_b64_tr_b16 v[184:185], v2 offset:12288
    ds_read_b64_tr_b16 v[186:187], v2 offset:26624
    ds_read_b64_tr_b16 v[188:189], v3 offset:12288
    ds_read_b64_tr_b16 v[190:191], v3 offset:26624
    ds_read_b64_tr_b16 v[192:193], v4 offset:12288
    ds_read_b64_tr_b16 v[194:195], v4 offset:26624
    ds_read_b64_tr_b16 v[196:197], v1 offset:28672
    ds_read_b64_tr_b16 v[198:199], v1 offset:30720
    ds_read_b64_tr_b16 v[200:201], v2 offset:28672
    ds_read_b64_tr_b16 v[202:203], v2 offset:30720
    ds_read_b64_tr_b16 v[204:205], v3 offset:28672
    ds_read_b64_tr_b16 v[206:207], v3 offset:30720
    ds_read_b64_tr_b16 v[208:209], v4 offset:28672
    ds_read_b64_tr_b16 v[210:211], v4 offset:30720
    ds_read_b64_tr_b16 v[212:213], v1 offset:32768
    ds_read_b64_tr_b16 v[214:215], v1 offset:34816
    ds_read_b64_tr_b16 v[216:217], v2 offset:32768
    ds_read_b64_tr_b16 v[218:219], v2 offset:34816
    ds_read_b64_tr_b16 v[220:221], v3 offset:32768
    ds_read_b64_tr_b16 v[222:223], v3 offset:34816
    ds_read_b64_tr_b16 v[224:225], v4 offset:32768
    ds_read_b64_tr_b16 v[226:227], v4 offset:34816
    ds_read_b64_tr_b16 v[228:229], v1 offset:36864
    ds_read_b64_tr_b16 v[230:231], v1 offset:38912
    ds_read_b64_tr_b16 v[232:233], v2 offset:36864
    ds_read_b64_tr_b16 v[234:235], v2 offset:38912
    ds_read_b64_tr_b16 v[236:237], v3 offset:36864
    ds_read_b64_tr_b16 v[238:239], v3 offset:38912
    ds_read_b64_tr_b16 v[240:241], v4 offset:36864
    ds_read_b64_tr_b16 v[242:243], v4 offset:38912
    s_mov_b32 s66, 0
    s_waitcnt vmcnt(0)
    s_branch L_chk_34
L_poll_32:
    buffer_load_dwordx2 v[8:9], v7, s[16:19], 0 offen sc1
    s_waitcnt vmcnt(0)
L_chk_34:
    v_xor_b32 v10, s6, v8
    v_xor_b32 v11, s7, v9
    v_or_b32 v10, v10, v11
    v_cmp_ne_u32 vcc, 0, v10
    s_add_u32 s66, s66, 1
    s_cmp_eq_u64 vcc, 0
    s_cbranch_scc1 L_polled_33
    s_cmp_lt_u32 s66, 1048576
    s_cbranch_scc0 L_polled_33
    s_mov_b64 exec, vcc
    s_branch L_poll_32
L_polled_33:
    s_mov_b64 exec, -1
    s_add_u32 s20, s72, 0
    buffer_load_dwordx4 v[12:15], v5, s[16:19], s20 offen offset:0 sc1
    buffer_load_dwordx4 v[16:19], v5, s[16:19], s20 offen offset:1024 sc1
    buffer_load_dwordx4 v[20:23], v5, s[16:19], s20 offen offset:2048 sc1
    s_add_u32 s20, s72, 12288
    buffer_load_dwordx4 v[24:27], v5, s[16:19], s20 offen offset:0 sc1
    buffer_load_dwordx4 v[28:31], v5, s[16:19], s20 offen offset:1024 sc1
    buffer_load_dwordx4 v[32:35], v5, s[16:19], s20 offen offset:2048 sc1
    s_add_u32 s20, s73, 0
    buffer_load_dwordx4 v[36:39], v6, s[16:19], s20 offen sc1
    s_add_u32 s20, s72, 24576
    buffer_load_dwordx4 v[40:43], v5, s[16:19], s20 offen offset:0 sc1
    buffer_load_dwordx4 v[44:47], v5, s[16:19], s20 offen offset:1024 sc1
    buffer_load_dwordx4 v[48:51], v5, s[16:19], s20 offen offset:2048 sc1
    s_add_u32 s20, s72, 36864
    buffer_load_dwordx4 v[52:55], v5, s[16:19], s20 offen offset:0 sc1
    buffer_load_dwordx4 v[56:59], v5, s[16:19], s20 offen offset:1024 sc1
    buffer_load_dwordx4 v[60:63], v5, s[16:19], s20 offen offset:2048 sc1
    s_add_u32 s20, s73, 4096
    buffer_load_dwordx4 v[64:67], v6, s[16:19], s20 offen sc1
    buffer_load_dwordx4 v[244:247], v252, s[16:19], s69 offen sc1
    s_waitcnt lgkmcnt(0)
    v_and_b32 v7, 15, v0
    s_lshl_b32 s20, s60, 4
    v_add_u32 v7, s20, v7
    s_mov_b32 s8, s50
    s_and_b32 s9, s51, 0xffff
    s_mov_b32 s10, 2097152
    s_mov_b32 s11, 0x20000
    s_lshl_b32 s20, s3, 11
    s_add_u32 s20, s20, 122880
    v_add_u32 v9, s20, v5
    s_xor_b32 s21, s3, 4
    s_lshl_b32 s21, s21, 11
    s_add_u32 s21, s21, 122880
    v_add_u32 v10, s21, v5
    v_sub_f32 v252, 1.0, v254
    v_cvt_pk_bf16_f32 v252, v252, v252
    v_lshlrev_b32 v252, 16, v252
    s_lshl_b32 s20, s4, 16
    s_lshl_b32 s21, s38, 7
    s_add_u32 s20, s20, s21
    s_lshl_b32 s21, s59, 6
    s_add_u32 s20, s20, s21
    v_lshlrev_b32 v7, 10, v7
    v_bfe_u32 v8, v0, 4, 1
    v_lshl_add_u32 v7, v8, 5, v7
    v_lshrrev_b32 v8, 5, v0
    v_lshl_add_u32 v7, v8, 4, v7
    s_waitcnt vmcnt(14)
    v_mfma_f32_16x16x32_bf16 v[68:71], v[84:87], v[12:15], 0
    v_mfma_f32_16x16x32_bf16 v[72:75], v[88:91], v[12:15], 0
    v_mfma_f32_16x16x32_bf16 v[76:79], v[92:95], v[12:15], 0
    v_mfma_f32_16x16x32_bf16 v[80:83], v[96:99], v[12:15], 0
    ds_read_b64_tr_b16 v[84:85], v1 offset:43008
    ds_read_b64_tr_b16 v[86:87], v1 offset:45056
    ds_read_b64_tr_b16 v[88:89], v2 offset:43008
    ds_read_b64_tr_b16 v[90:91], v2 offset:45056
    ds_read_b64_tr_b16 v[92:93], v3 offset:43008
    ds_read_b64_tr_b16 v[94:95], v3 offset:45056
    ds_read_b64_tr_b16 v[96:97], v4 offset:43008
    ds_read_b64_tr_b16 v[98:99], v4 offset:45056
    s_waitcnt vmcnt(13)
    v_mfma_f32_16x16x32_bf16 v[68:71], v[100:103], v[16:19], v[68:71]
    v_mfma_f32_16x16x32_bf16 v[72:75], v[104:107], v[16:19], v[72:75]
    v_mfma_f32_16x16x32_bf16 v[76:79], v[108:111], v[16:19], v[76:79]
    v_mfma_f32_16x16x32_bf16 v[80:83], v[112:115], v[16:19], v[80:83]
    ds_read_b64_tr_b16 v[100:101], v1 offset:47104
    ds_read_b64_tr_b16 v[102:103], v1 offset:49152
    ds_read_b64_tr_b16 v[104:105], v2 offset:47104
    ds_read_b64_tr_b16 v[106:107], v2 offset:49152
    ds_read_b64_tr_b16 v[108:109], v3 offset:47104
    ds_read_b64_tr_b16 v[110:111], v3 offset:49152
    ds_read_b64_tr_b16 v[112:113], v4 offset:47104
    ds_read_b64_tr_b16 v[114:115], v4 offset:49152
    s_waitcnt vmcnt(12)
    v_mfma_f32_16x16x32_bf16 v[68:71], v[116:119], v[20:23], v[68:71]
    v_mfma_f32_16x16x32_bf16 v[72:75], v[120:123], v[20:23], v[72:75]
    v_mfma_f32_16x16x32_bf16 v[76:79], v[124:127], v[20:23], v[76:79]
    v_mfma_f32_16x16x32_bf16 v[80:83], v[128:131], v[20:23], v[80:83]
    ds_read_b64_tr_b16 v[116:117], v1 offset:51200
    ds_read_b64_tr_b16 v[118:119], v1 offset:53248
    ds_read_b64_tr_b16 v[120:121], v2 offset:51200
    ds_read_b64_tr_b16 v[122:123], v2 offset:53248
    ds_read_b64_tr_b16 v[124:125], v3 offset:51200
    ds_read_b64_tr_b16 v[126:127], v3 offset:53248
    ds_read_b64_tr_b16 v[128:129], v4 offset:51200
    ds_read_b64_tr_b16 v[130:131], v4 offset:53248
    s_waitcnt vmcnt(11)
    v_mfma_f32_16x16x32_bf16 v[68:71], v[132:135], v[24:27], v[68:71]
    v_mfma_f32_16x16x32_bf16 v[72:75], v[136:139], v[24:27], v[72:75]
    v_mfma_f32_16x16x32_bf16 v[76:79], v[140:143], v[24:27], v[76:79]
    v_mfma_f32_16x16x32_bf16 v[80:83], v[144:147], v[24:27], v[80:83]
    ds_read_b64_tr_b16 v[132:133], v1 offset:40960
    ds_read_b64_tr_b16 v[134:135], v1 offset:55296
    ds_read_b64_tr_b16 v[136:137], v2 offset:40960
    ds_read_b64_tr_b16 v[138:139], v2 offset:55296
    ds_read_b64_tr_b16 v[140:141], v3 offset:40960
    ds_read_b64_tr_b16 v[142:143], v3 offset:55296
    ds_read_b64_tr_b16 v[144:145], v4 offset:40960
    ds_read_b64_tr_b16 v[146:147], v4 offset:55296
    s_waitcnt vmcnt(10)
    v_mfma_f32_16x16x32_bf16 v[68:71], v[148:151], v[28:31], v[68:71]
    v_mfma_f32_16x16x32_bf16 v[72:75], v[152:155], v[28:31], v[72:75]
    v_mfma_f32_16x16x32_bf16 v[76:79], v[156:159], v[28:31], v[76:79]
    v_mfma_f32_16x16x32_bf16 v[80:83], v[160:163], v[28:31], v[80:83]
    s_waitcnt vmcnt(9)
    v_mfma_f32_16x16x32_bf16 v[68:71], v[164:167], v[32:35], v[68:71]
    v_mfma_f32_16x16x32_bf16 v[72:75], v[168:171], v[32:35], v[72:75]
    v_mfma_f32_16x16x32_bf16 v[76:79], v[172:175], v[32:35], v[76:79]
    v_mfma_f32_16x16x32_bf16 v[80:83], v[176:179], v[32:35], v[80:83]
    s_waitcnt vmcnt(8)
    v_permlane32_swap_b32 v36, v38
    v_permlane32_swap_b32 v37, v39
    s_nop 1
    v_mfma_f32_16x16x32_bf16 v[68:71], v[180:183], v[36:39], v[68:71]
    v_mfma_f32_16x16x32_bf16 v[72:75], v[184:187], v[36:39], v[72:75]
    v_mfma_f32_16x16x32_bf16 v[76:79], v[188:191], v[36:39], v[76:79]
    v_mfma_f32_16x16x32_bf16 v[80:83], v[192:195], v[36:39], v[80:83]
    s_waitcnt vmcnt(7)
    v_mfma_f32_16x16x32_bf16 v[68:71], v[196:199], v[40:43], v[68:71]
    v_mfma_f32_16x16x32_bf16 v[72:75], v[200:203], v[40:43], v[72:75]
    v_mfma_f32_16x16x32_bf16 v[76:79], v[204:207], v[40:43], v[76:79]
    v_mfma_f32_16x16x32_bf16 v[80:83], v[208:211], v[40:43], v[80:83]
    s_waitcnt vmcnt(6)
    v_mfma_f32_16x16x32_bf16 v[68:71], v[212:215], v[44:47], v[68:71]
    v_mfma_f32_16x16x32_bf16 v[72:75], v[216:219], v[44:47], v[72:75]
    v_mfma_f32_16x16x32_bf16 v[76:79], v[220:223], v[44:47], v[76:79]
    v_mfma_f32_16x16x32_bf16 v[80:83], v[224:227], v[44:47], v[80:83]
    s_waitcnt vmcnt(5)
    v_mfma_f32_16x16x32_bf16 v[68:71], v[228:231], v[48:51], v[68:71]
    v_mfma_f32_16x16x32_bf16 v[72:75], v[232:235], v[48:51], v[72:75]
    v_mfma_f32_16x16x32_bf16 v[76:79], v[236:239], v[48:51], v[76:79]
    v_mfma_f32_16x16x32_bf16 v[80:83], v[240:243], v[48:51], v[80:83]
    s_waitcnt vmcnt(4) lgkmcnt(0)
    v_mfma_f32_16x16x32_bf16 v[68:71], v[84:87], v[52:55], v[68:71]
    v_mfma_f32_16x16x32_bf16 v[72:75], v[88:91], v[52:55], v[72:75]
    v_mfma_f32_16x16x32_bf16 v[76:79], v[92:95], v[52:55], v[76:79]
    v_mfma_f32_16x16x32_bf16 v[80:83], v[96:99], v[52:55], v[80:83]
    s_waitcnt vmcnt(3)
    v_mfma_f32_16x16x32_bf16 v[68:71], v[100:103], v[56:59], v[68:71]
    v_mfma_f32_16x16x32_bf16 v[72:75], v[104:107], v[56:59], v[72:75]
    v_mfma_f32_16x16x32_bf16 v[76:79], v[108:111], v[56:59], v[76:79]
    v_mfma_f32_16x16x32_bf16 v[80:83], v[112:115], v[56:59], v[80:83]
    s_waitcnt vmcnt(2)
    v_mfma_f32_16x16x32_bf16 v[68:71], v[116:119], v[60:63], v[68:71]
    v_mfma_f32_16x16x32_bf16 v[72:75], v[120:123], v[60:63], v[72:75]
    v_mfma_f32_16x16x32_bf16 v[76:79], v[124:127], v[60:63], v[76:79]
    v_mfma_f32_16x16x32_bf16 v[80:83], v[128:131], v[60:63], v[80:83]
    s_waitcnt vmcnt(1)
    v_permlane32_swap_b32 v64, v66
    v_permlane32_swap_b32 v65, v67
    s_nop 1
    v_mfma_f32_16x16x32_bf16 v[68:71], v[132:135], v[64:67], v[68:71]
    v_mfma_f32_16x16x32_bf16 v[72:75], v[136:139], v[64:67], v[72:75]
    v_mfma_f32_16x16x32_bf16 v[76:79], v[140:143], v[64:67], v[76:79]
    v_mfma_f32_16x16x32_bf16 v[80:83], v[144:147], v[64:67], v[80:83]
    s_waitcnt vmcnt(0)
    ds_write_b128 v251, v[244:247]
    s_cmp_eq_u32 s59, 1
    s_cbranch_scc1 L_rx_35
    s_nop 2
    ds_write_b128 v9, v[76:79]
    ds_write_b128 v9, v[80:83] offset:1024
    s_branch L_rxd_36
L_rx_35:
    s_nop 0
    ds_write_b128 v9, v[68:71]
    ds_write_b128 v9, v[72:75] offset:1024
    s_nop 0
    v_mov_b32 v68, v76
    v_mov_b32 v69, v77
    v_mov_b32 v70, v78
    v_mov_b32 v71, v79
    v_mov_b32 v72, v80
    v_mov_b32 v73, v81
    v_mov_b32 v74, v82
    v_mov_b32 v75, v83
L_rxd_36:
    s_waitcnt lgkmcnt(0)
    s_barrier
    ds_read_b64_tr_b16 v[246:247], v250 offset:0
    ds_read_b64_tr_b16 v[248:249], v250 offset:2048
    ds_read_b128 v[20:23], v10
    ds_read_b128 v[24:27], v10 offset:1024
    s_waitcnt lgkmcnt(2)
    v_lshlrev_b32 v12, 16, v246
    v_and_b32 v13, 0xffff0000, v246
    v_lshlrev_b32 v14, 16, v247
    v_and_b32 v15, 0xffff0000, v247
    v_lshlrev_b32 v16, 16, v248
    v_and_b32 v17, 0xffff0000, v248
    v_lshlrev_b32 v18, 16, v249
    v_and_b32 v19, 0xffff0000, v249
    v_mul_f32 v12, v12, v254
    v_mul_f32 v13, v13, v254
    v_mul_f32 v14, v14, v254
    v_mul_f32 v15, v15, v254
    v_mul_f32 v16, v16, v254
    v_mul_f32 v17, v17, v254
    v_mul_f32 v18, v18, v254
    v_mul_f32 v19, v19, v254
    s_waitcnt lgkmcnt(0)
    v_add_f32 v20, v20, v68
    v_add_f32 v21, v21, v69
    v_add_f32 v22, v22, v70
    v_add_f32 v23, v23, v71
    v_add_f32 v24, v24, v72
    v_add_f32 v25, v25, v73
    v_add_f32 v26, v26, v74
    v_add_f32 v27, v27, v75
    v_fmac_f32 v12, v252, v20
    v_fmac_f32 v13, v252, v21
    v_fmac_f32 v14, v252, v22
    v_fmac_f32 v15, v252, v23
    v_fmac_f32 v16, v252, v24
    v_fmac_f32 v17, v252, v25
    v_fmac_f32 v18, v252, v26
    v_fmac_f32 v19, v252, v27
    v_cvt_pk_bf16_f32 v28, v12, v13
    v_cvt_pk_bf16_f32 v29, v14, v15
    v_cvt_pk_bf16_f32 v30, v16, v17
    v_cvt_pk_bf16_f32 v31, v18, v19
    s_nop 0
    v_permlane16_swap_b32 v28, v30
    v_permlane16_swap_b32 v29, v31
    buffer_store_dwordx4 v[28:31], v7, s[8:11], s20 offen
L_end:
    s_endpgm
.section .rodata,"a"
.p2align 6
.amdhsa_kernel gated_mix__ssm_conv_s4d__mixer_gmlp__prompt_kernel
  .amdhsa_next_free_vgpr 256
  .amdhsa_next_free_sgpr 102
  .amdhsa_accum_offset 256
  .amdhsa_group_segment_fixed_size 0
  .amdhsa_kernarg_size 128
  .amdhsa_user_sgpr_count 2
  .amdhsa_user_sgpr_kernarg_segment_ptr 1
  .amdhsa_system_sgpr_workgroup_id_x 1
  .amdhsa_float_denorm_mode_32 3
.end_amdhsa_kernel
```
